```python
import torch

def _softmax(x, axis=-1):
    return torch.softmax(x, dim=axis)
def _gelu(x):
    return torch.nn.functional.gelu(x, approximate="tanh")
def _silu(x):
    return torch.nn.functional.silu(x)
def _sigmoid(x):
    return torch.sigmoid(x)
def _layernorm(x, axis=-1, eps=1e-5):
    m = x.mean(dim=axis, keepdim=True)
    v = x.var(dim=axis, keepdim=True, unbiased=False)
    return (x - m) / torch.sqrt(v + eps)
def _scatter_add(tgt, idx, src, axis=0):
    return tgt.clone().index_add_(axis, idx, src)
def _segment_sum(src, seg, n):
    out = torch.zeros((n,) + src.shape[1:], dtype=src.dtype)
    return out.index_add_(0, seg, src)
def _pad(x, pw):
    flat = tuple(v for pair in reversed(pw) for v in pair)
    return torch.nn.functional.pad(x, flat)

kernel_name = 'standalone__grouped_kv_mqa__prompt'

def setup_inputs():

    _w = (lambda a: (lambda t: t.to(torch.bfloat16) if t.is_floating_point() else t)(torch.as_tensor(a)))
    B, S, D, H = 1, 2048, 1024, 32
    Dh = D // H
    return {
        "x": _w((lambda *s: torch.randn(*s, dtype=torch.bfloat16) * 0.05)(B, S, D)),
        "wq": _w((lambda *s: torch.randn(*s, dtype=torch.bfloat16) * 0.8)(D, H * Dh)),
        "wk": _w((lambda *s: torch.randn(*s, dtype=torch.bfloat16) * 0.8)(D, Dh)),
        "wv": _w((lambda *s: torch.randn(*s, dtype=torch.bfloat16) * 0.05)(D, Dh)),
        "wo": _w((lambda *s: torch.randn(*s, dtype=torch.bfloat16) * 0.05)(H * Dh, D)),
    }

def reference(x, wq, wk, wv, wo):
    B, S, D = x.shape
    H = 32
    Dh = D // H
    q = (lambda x, *d: x.permute(*d))((x @ wq).reshape(B, S, H, Dh), 0, 2, 1, 3)
    k = x @ wk
    v = x @ wv
    scores = torch.einsum("bhqd,bkd->bhqk", q, k) * (Dh ** -0.5)
    p = _softmax(scores, axis=-1)
    o = torch.einsum("bhqk,bkd->bhqd", p, v)
    return (lambda x, *d: x.permute(*d))(o, 0, 2, 1, 3).reshape(B, S, H * Dh) @ wo
```

```asm
; @launch grid=(256,1,1) block=(256,1,1) lds=163840
.amdgcn_target "amdgcn-amd-amdhsa--gfx950"
.text
.globl standalone__grouped_kv_mqa__prompt_kernel
.p2align 12
.p2align 8
.type standalone__grouped_kv_mqa__prompt_kernel,@function
standalone__grouped_kv_mqa__prompt_kernel:
    s_cmp_ge_u32 s2, 256
    s_cbranch_scc1 L_end
    s_load_dwordx16 s[48:63], s[0:1], 0
    s_getpc_b64 s[46:47]
    s_bfe_u32 s40, s2, 0x30003
    s_lshl_b32 s40, s40, 12
    v_lshl_add_u32 v6, v0, 4, s40
    v_mov_b32 v7, 0
    v_lshl_add_u64 v[6:7], v[6:7], 0, s[46:47]
    global_load_dwordx4 v[24:27], v[6:7], off offset:488
    v_lshrrev_b32 v1, 6, v0
    v_and_b32 v0, 63, v0
    v_readfirstlane_b32 s38, v1
    s_and_b32 s40, s2, 7
    s_bfe_u32 s41, s2, 0x10003
    s_lshl1_add_u32 s36, s40, s41
    s_lshr_b32 s37, s2, 4
    s_and_b32 s40, s2, 3
    s_bfe_u32 s41, s2, 0x20003
    s_lshl2_add_u32 s36, s40, s41
    s_bfe_u32 s42, s2, 0x10002
    s_lshr_b32 s37, s2, 5
    s_lshl3_add_u32 s37, s42, s37
    s_lshl2_add_u32 s39, s41, s40
    s_mov_b32 s45, s37
    v_lshrrev_b32 v2, 3, v0
    v_lshrrev_b32 v3, 4, v0
    v_and_b32 v4, 7, v0
    v_lshlrev_b32 v2, 11, v2
    v_xor_b32 v5, v4, v3
    v_lshl_add_u32 v148, v5, 4, v2
    s_movk_i32 s69, 15360
    v_xad_u32 v149, v148, 64, s69
    v_and_b32 v5, 1, v3
    v_lshlrev_b32 v5, 1, v5
    v_xor_b32 v5, v5, v4
    v_lshl_add_u32 v5, v5, 4, v2
    v_lshl_add_u32 v140, v1, 15, v5
    v_xad_u32 v141, v140, 64, s69
    v_and_b32 v5, 2, v3
    v_xor_b32 v5, v5, v0
    v_lshlrev_b32 v5, 4, v5
    v_lshl_add_u32 v150, v1, 14, v5
    s_lshr_b32 s42, s45, 1
    s_lshl_b32 s42, s42, 6
    s_add_u32 s42, s42, s38
    s_lshl_b32 s47, s42, 9
    s_lshr_b32 s46, s45, 1
    s_xor_b32 s46, s46, s45
    s_and_b32 s46, s46, 1
    s_lshl_b32 s42, s46, 8
    s_add_u32 s47, s47, s42
    s_lshl_b32 s46, s46, 13
    s_add_u32 s43, s38, 12
    s_lshl_b32 s43, s43, 13
    s_lshl_b32 s40, s36, 18
    s_lshl_b32 s41, s37, 7
    s_mul_i32 s64, s38, 24576
    s_add_u32 s65, s38, 48
    s_lshl_b32 s65, s65, 11
    s_mov_b32 s6, 0x40000
    s_mov_b32 s7, 0x20000
    s_mov_b32 s11, s7
    s_mov_b32 s15, s7
    s_sub_u32 s10, 0x200000, s41
    s_lshr_b32 s14, s6, 2
    s_waitcnt lgkmcnt(0)
    s_add_u32 s4, s48, s40
    s_addc_u32 s5, s49, 0
    s_bitcmp1_b32 s45, 0
    s_cselect_b64 s[12:13], s[54:55], s[52:53]
    s_cselect_b32 s66, 1.0, 0x3e8293ee
    s_add_u32 m0, s43, 0
    s_xor_b32 s41, s47, 0
    buffer_load_dwordx4 v148, s[4:7], s41 offen lds
    buffer_load_dwordx4 v149, s[4:7], s41 offen offset:1024 lds
    s_add_u32 m0, s64, 0
    s_xor_b32 s41, s46, 0
    buffer_load_dwordx4 v150, s[12:15], s41 offen offset:0 lds
    buffer_load_dwordx4 v150, s[12:15], s41 offen offset:1024 lds
    buffer_load_dwordx4 v150, s[12:15], s41 offen offset:2048 lds
    buffer_load_dwordx4 v150, s[12:15], s41 offen offset:3072 lds
    s_add_u32 m0, s43, 2048
    s_xor_b32 s41, s47, 128
    buffer_load_dwordx4 v148, s[4:7], s41 offen lds
    buffer_load_dwordx4 v149, s[4:7], s41 offen offset:1024 lds
    s_add_u32 m0, s64, 4096
    s_xor_b32 s41, s46, 4096
    buffer_load_dwordx4 v150, s[12:15], s41 offen offset:0 lds
    buffer_load_dwordx4 v150, s[12:15], s41 offen offset:1024 lds
    buffer_load_dwordx4 v150, s[12:15], s41 offen offset:2048 lds
    buffer_load_dwordx4 v150, s[12:15], s41 offen offset:3072 lds
    s_add_u32 s24, s62, 524288
    s_addc_u32 s25, s63, 0
    s_mov_b32 s26, 4096
    s_mov_b32 s27, 0x20000
    s_load_dword s3, s[24:25], 4092
    s_mov_b32 s28, s62
    s_mov_b32 s29, s63
    s_mov_b32 s30, 262144
    s_mov_b32 s31, 0x20000
    v_lshl_add_u32 v136, v1, 16, v148
    v_lshl_add_u32 v137, v1, 16, v149
    v_add_u32 v138, 30720, v136
    v_add_u32 v139, 30720, v137
    v_and_b32 v5, 15, v0
    v_lshlrev_b32 v37, 4, v0
    v_lshrrev_b32 v6, 1, v5
    v_xor_b32 v6, v6, v3
    v_lshlrev_b32 v6, 4, v6
    v_lshl_add_u32 v6, v5, 7, v6
    v_add_u32 v151, s43, v6
    v_xor_b32 v152, 64, v151
    v_add_u32 v142, s64, v6
    v_xor_b32 v143, 64, v142
    v_lshrrev_b32 v6, 2, v5
    v_and_b32 v7, 3, v5
    v_lshlrev_b32 v7, 3, v7
    v_lshl_add_u32 v1, v3, 3, v6
    v_and_b32 v2, 1, v3
    v_lshl_add_u32 v4, v2, 5, v7
    v_lshl_add_u32 v4, v1, 6, v4
    v_add_u32 v153, s64, v4
    v_xor_b32 v154, 32, v153
    v_lshrrev_b32 v4, 3, v5
    v_lshl_or_b32 v4, v2, 1, v4
    v_lshl_add_u32 v7, v4, 5, v7
    v_lshl_add_u32 v4, v1, 7, v7
    v_add_u32 v144, 98304, v4
    v_xor_b32 v145, 32, v144
    v_xor_b32 v146, 64, v144
    v_xor_b32 v147, 96, v144
    s_add_u32 s40, s38, 72
    s_lshl_b32 s40, s40, 11
    v_add_u32 v45, s40, v37
    v_lshrrev_b32 v4, 1, v3
    v_lshl_add_u32 v4, v4, 5, v5
    v_lshlrev_b32 v4, 4, v4
    v_lshl_add_u32 v1, v2, 10, v4
    v_add_u32 v156, 147456, v1
    v_lshl_add_u32 v4, v2, 3, v4
    v_add_u32 v36, s40, v4
    s_lshr_b32 s40, s45, 2
    s_lshl2_add_u32 s40, s36, s40
    s_lshl_b32 s40, s40, 12
    s_bfe_u32 s69, s45, 0x10001
    s_lshl_b32 s42, s69, 8
    s_lshl_b32 s69, s69, 10
    s_add_u32 s69, s69, 2048
    s_bitcmp1_b32 s45, 0
    s_cselect_b32 s69, s69, s42
    s_cselect_b64 vcc, -1, 0
    s_add_u32 s40, s40, s69
    s_lshl_b32 s69, s38, 18
    s_add_u32 s40, s40, s69
    v_cndmask_b32 v1, v1, v37, vcc
    v_add_u32 v157, s40, v1
    s_lshl4_add_u32 s71, s36, s37
    s_lshl_b32 s71, s71, 4
    s_lshl_b32 s40, s38, 14
    s_add_u32 s71, s71, s40
    s_mov_b32 s44, 0
    s_lshl_b32 s67, s38, 16
    s_lshl_b32 s42, s36, 18
    s_lshl_b32 s69, s37, 7
    s_sub_u32 s18, 0x70000, s69
    s_add_u32 s16, s56, s69
    s_addc_u32 s17, s57, 0
    s_mov_b32 s19, 0x20000
    s_sub_u32 s22, 0x40000, s69
    s_add_u32 s69, s69, s42
    s_add_u32 s20, s58, s69
    s_addc_u32 s21, s59, 0
    s_mov_b32 s23, 0x20000
    s_add_u32 s42, s42, 1048576
    s_add_u32 s32, s62, s42
    s_addc_u32 s33, s63, 0
    s_mov_b32 s34, 0x40000
    s_mov_b32 s35, 0x20000
    s_lshl_b32 s42, s38, 12
    s_sub_u32 s68, 159744, s42
    s_mul_i32 s70, s38, 4352
    s_lshl_b32 s41, s37, 7
    s_add_u32 s8, s50, s41
    s_addc_u32 s9, s51, 0
    s_lshl_b32 s39, s39, 17
    s_add_u32 m0, s65, 32768
    s_and_b32 s39, s39, 0x1e0000
    buffer_load_dwordx4 v140, s[8:11], s39 offen offset:0 lds
    v_lshrrev_b32 v4, 1, v3
    v_lshl_add_u32 v46, v2, 2, v6
    v_lshl_add_u32 v46, v4, 4, v46
    v_lshl_add_u32 v46, v46, 7, v7
    v_add_u32 v16, 98304, v46
    v_xor_b32 v17, 32, v16
    v_xor_b32 v18, 64, v16
    v_xor_b32 v19, 96, v16
    v_subrev_u32 v20, 0x10000, v16
    buffer_load_dwordx4 v141, s[8:11], s39 offen offset:1024 lds
    v_subrev_u32 v21, 0x10000, v17
    v_subrev_u32 v22, 0x10000, v18
    v_subrev_u32 v23, 0x10000, v19
    s_add_u32 s42, s38, 3
    s_and_b32 s42, s42, 3
    s_lshl_b32 s42, s42, 16
    s_lshl_b32 s69, s37, 11
    s_add_u32 s42, s42, s69
    v_lshlrev_b32 v46, 4, v5
    s_mov_b64 exec, 0
    s_cmp_eq_u32 s38, 0
    s_cbranch_scc1 L_pad0
    s_cmp_eq_u32 s38, 1
    s_cbranch_scc1 L_pad2
    s_cmp_eq_u32 s38, 2
    s_cbranch_scc1 L_pad4
    s_branch L_pad6
L_padback:
    s_mov_b64 exec, -1
    s_add_u32 m0, s43, 4096
    s_xor_b32 s41, s47, 256
    buffer_load_dwordx4 v148, s[4:7], s41 offen lds
    v_lshl_add_u32 v46, v2, 10, v46
    v_lshl_add_u32 v46, v4, 8, v46
    v_add_u32 v9, s42, v46
    v_add_u32 v47, 0x8000, v9
    s_lshl_b32 s42, s36, 8
    v_lshl_add_u32 v39, v5, 4, s42
    s_mul_i32 s69, s38, 4608
    v_mul_u32_u24 v46, 144, v5
    v_lshl_add_u32 v46, v3, 3, v46
    buffer_load_dwordx4 v149, s[4:7], s41 offen offset:1024 lds
    v_add_u32 v11, s69, v46
    v_lshrrev_b32 v2, 3, v0
    v_and_b32 v4, 7, v0
    v_lshlrev_b32 v46, 1, v3
    v_xor_b32 v46, v46, v4
    v_lshlrev_b32 v46, 4, v46
    v_lshl_add_u32 v46, v2, 11, v46
    s_lshl_b32 s42, s38, 17
    v_add_u32 v32, s42, v46
    s_add_u32 m0, s64, 8192
    s_xor_b32 s41, s46, 8192
    buffer_load_dwordx4 v150, s[12:15], s41 offen offset:0 lds
    v_add_u32 v33, 15360, v32
    v_add_u32 v34, 30720, v32
    v_add_u32 v35, 46080, v32
    v_lshlrev_b32 v4, 4, v4
    v_lshl_add_u32 v46, v2, 11, v4
    s_lshl_b32 s42, s38, 16
    v_add_u32 v13, s42, v46
    v_mul_u32_u24 v46, 144, v2
    v_add3_u32 v12, v46, v4, s69
    buffer_load_dwordx4 v150, s[12:15], s41 offen offset:1024 lds
    v_lshrrev_b32 v46, 2, v0
    v_lshlrev_b32 v46, 11, v46
    s_add_u32 s42, s42, 2032
    v_add_u32 v10, s42, v46
    v_add_u32 v14, s70, v37
    s_add_u32 s42, s38, 1
    s_and_b32 s42, s42, 3
    s_mul_i32 s42, s42, 4352
    v_add_u32 v15, s42, v37
    buffer_load_dwordx4 v150, s[12:15], s41 offen offset:2048 lds
    v_lshl_add_u32 v8, v0, 2, s42
    s_add_u32 s42, s38, 1
    s_and_b32 s42, s42, 3
    s_add_u32 s42, s42, 72
    s_lshl_b32 s42, s42, 11
    v_add_u32 v28, s42, v37
    s_add_u32 s42, s38, 2
    s_and_b32 s42, s42, 3
    s_add_u32 s42, s42, 72
    buffer_load_dwordx4 v150, s[12:15], s41 offen offset:3072 lds
    s_lshl_b32 s42, s42, 11
    v_add_u32 v29, s42, v37
    s_add_u32 s42, s38, 3
    s_and_b32 s42, s42, 3
    s_add_u32 s42, s42, 72
    s_lshl_b32 s42, s42, 11
    v_add_u32 v30, s42, v37
    v_mov_b32 v44, 0xdddddddd
    v_and_b32 v2, 7, v0
    s_add_u32 m0, s43, 6144
    s_xor_b32 s41, s47, 384
    buffer_load_dwordx4 v148, s[4:7], s41 offen lds
    v_mov_b32 v3, 0x3f803f80
    v_cmp_eq_u32 vcc, 0, v2
    s_nop 1
    v_cndmask_b32 v40, 0, v3, vcc
    v_cndmask_b32 v41, 0, v3, vcc
    v_cmp_eq_u32 vcc, 4, v2
    s_nop 1
    v_cndmask_b32 v42, 0, v3, vcc
    v_cndmask_b32 v43, 0, v3, vcc
    buffer_load_dwordx4 v149, s[4:7], s41 offen offset:1024 lds
    v_mov_b32 v96, 0
    v_mov_b32 v97, 0
    v_mov_b32 v98, 0
    v_mov_b32 v99, 0
    v_mov_b32 v100, 0
    v_mov_b32 v101, 0
    v_mov_b32 v102, 0
    v_mov_b32 v103, 0
    v_mov_b32 v104, 0
    s_add_u32 m0, s64, 12288
    s_xor_b32 s41, s46, 12288
    buffer_load_dwordx4 v150, s[12:15], s41 offen offset:0 lds
    v_mov_b32 v105, 0
    v_mov_b32 v106, 0
    v_mov_b32 v107, 0
    v_mov_b32 v108, 0
    v_mov_b32 v109, 0
    v_mov_b32 v110, 0
    v_mov_b32 v111, 0
    v_mov_b32 v112, 0
    v_mov_b32 v113, 0
    buffer_load_dwordx4 v150, s[12:15], s41 offen offset:1024 lds
    v_mov_b32 v114, 0
    v_mov_b32 v115, 0
    v_mov_b32 v116, 0
    v_mov_b32 v117, 0
    v_mov_b32 v118, 0
    v_mov_b32 v119, 0
    v_mov_b32 v120, 0
    v_mov_b32 v121, 0
    v_mov_b32 v122, 0
    buffer_load_dwordx4 v150, s[12:15], s41 offen offset:2048 lds
    v_mov_b32 v123, 0
    v_mov_b32 v124, 0
    v_mov_b32 v125, 0
    v_mov_b32 v126, 0
    v_mov_b32 v127, 0
    v_mov_b32 v128, 0
    v_mov_b32 v129, 0
    v_mov_b32 v130, 0
    v_mov_b32 v131, 0
    buffer_load_dwordx4 v150, s[12:15], s41 offen offset:3072 lds
    v_mov_b32 v132, 0
    v_mov_b32 v133, 0
    v_mov_b32 v134, 0
    v_mov_b32 v135, 0
    v_mov_b32 v4, -1
    v_mov_b32 v5, -1
    v_mov_b32 v6, -1
    v_mov_b32 v7, -1
    v_lshl_add_u32 v2, v0, 16, s71
    s_bitcmp1_b32 s45, 0
    s_cbranch_scc1 L_kvV1
    s_waitcnt vmcnt(24)
    s_waitcnt vmcnt(20)
    ds_read_b128 a[0:3], v151 offset:0
    ds_read_b64_tr_b16 a[32:33], v153 offset:0
    ds_read_b64_tr_b16 a[34:35], v153 offset:256
    ds_read_b64_tr_b16 a[36:37], v154 offset:0
    ds_read_b64_tr_b16 a[38:39], v154 offset:256
    ds_read_b128 a[4:7], v152 offset:0
    ds_read_b64_tr_b16 a[40:41], v153 offset:2048
    ds_read_b64_tr_b16 a[42:43], v153 offset:2304
    ds_read_b64_tr_b16 a[44:45], v154 offset:2048
    ds_read_b64_tr_b16 a[46:47], v154 offset:2304
    s_add_u32 m0, s64, 16384
    s_lshr_b32 s40, s39, 10
    buffer_load_dwordx4 v136, s[4:7], s40 offen offset:0 lds
    buffer_load_dwordx4 v137, s[4:7], s40 offen offset:1024 lds
    buffer_load_dwordx4 v138, s[4:7], s40 offen offset:2048 lds
    buffer_load_dwordx4 v139, s[4:7], s40 offen offset:3072 lds
    s_waitcnt lgkmcnt(5)
    v_mfma_f32_16x16x32_bf16 v[80:83], a[32:35], a[0:3], 0
    v_mfma_f32_16x16x32_bf16 v[84:87], a[36:39], a[0:3], 0
    s_waitcnt lgkmcnt(0)
    v_mfma_f32_16x16x32_bf16 v[80:83], a[40:43], a[4:7], v[80:83]
    v_mfma_f32_16x16x32_bf16 v[84:87], a[44:47], a[4:7], v[84:87]
    s_waitcnt vmcnt(22)
    s_waitcnt vmcnt(18)
    ds_read_b128 a[8:11], v151 offset:2048
    ds_read_b64_tr_b16 a[48:49], v153 offset:4096
    ds_read_b64_tr_b16 a[50:51], v153 offset:4352
    ds_read_b64_tr_b16 a[52:53], v154 offset:4096
    ds_read_b64_tr_b16 a[54:55], v154 offset:4352
    ds_read_b128 a[12:15], v152 offset:2048
    ds_read_b64_tr_b16 a[56:57], v153 offset:6144
    ds_read_b64_tr_b16 a[58:59], v153 offset:6400
    ds_read_b64_tr_b16 a[60:61], v154 offset:6144
    ds_read_b64_tr_b16 a[62:63], v154 offset:6400
    s_add_u32 s39, s39, s7
    s_add_u32 m0, s65, 40960
    s_and_b32 s39, s39, 0x1e0000
    buffer_load_dwordx4 v140, s[8:11], s39 offen offset:0 lds
    buffer_load_dwordx4 v141, s[8:11], s39 offen offset:1024 lds
    s_waitcnt lgkmcnt(5)
    v_mfma_f32_16x16x32_bf16 v[80:83], a[48:51], a[8:11], v[80:83]
    v_mfma_f32_16x16x32_bf16 v[84:87], a[52:55], a[8:11], v[84:87]
    s_waitcnt lgkmcnt(0)
    v_mfma_f32_16x16x32_bf16 v[80:83], a[56:59], a[12:15], v[80:83]
    v_mfma_f32_16x16x32_bf16 v[84:87], a[60:63], a[12:15], v[84:87]
    s_waitcnt vmcnt(16)
    s_waitcnt vmcnt(12)
    ds_read_b128 a[16:19], v151 offset:4096
    ds_read_b64_tr_b16 a[64:65], v153 offset:8192
    ds_read_b64_tr_b16 a[66:67], v153 offset:8448
    ds_read_b64_tr_b16 a[68:69], v154 offset:8192
    ds_read_b64_tr_b16 a[70:71], v154 offset:8448
    ds_read_b128 a[20:23], v152 offset:4096
    ds_read_b64_tr_b16 a[72:73], v153 offset:10240
    ds_read_b64_tr_b16 a[74:75], v153 offset:10496
    ds_read_b64_tr_b16 a[76:77], v154 offset:10240
    ds_read_b64_tr_b16 a[78:79], v154 offset:10496
    s_add_u32 m0, s64, 20480
    s_lshr_b32 s40, s39, 10
    buffer_load_dwordx4 v136, s[4:7], s40 offen offset:0 lds
    buffer_load_dwordx4 v137, s[4:7], s40 offen offset:1024 lds
    buffer_load_dwordx4 v138, s[4:7], s40 offen offset:2048 lds
    buffer_load_dwordx4 v139, s[4:7], s40 offen offset:3072 lds
    s_waitcnt lgkmcnt(5)
    v_mfma_f32_16x16x32_bf16 v[80:83], a[64:67], a[16:19], v[80:83]
    v_mfma_f32_16x16x32_bf16 v[84:87], a[68:71], a[16:19], v[84:87]
    s_waitcnt lgkmcnt(0)
    v_mfma_f32_16x16x32_bf16 v[80:83], a[72:75], a[20:23], v[80:83]
    v_mfma_f32_16x16x32_bf16 v[84:87], a[76:79], a[20:23], v[84:87]
    s_waitcnt vmcnt(14)
    s_waitcnt vmcnt(10)
    ds_read_b128 a[24:27], v151 offset:6144
    ds_read_b64_tr_b16 a[80:81], v153 offset:12288
    ds_read_b64_tr_b16 a[82:83], v153 offset:12544
    ds_read_b64_tr_b16 a[84:85], v154 offset:12288
    ds_read_b64_tr_b16 a[86:87], v154 offset:12544
    ds_read_b128 a[28:31], v152 offset:6144
    ds_read_b64_tr_b16 a[88:89], v153 offset:14336
    ds_read_b64_tr_b16 a[90:91], v153 offset:14592
    ds_read_b64_tr_b16 a[92:93], v154 offset:14336
    ds_read_b64_tr_b16 a[94:95], v154 offset:14592
    s_waitcnt lgkmcnt(5)
    v_mfma_f32_16x16x32_bf16 v[80:83], a[80:83], a[24:27], v[80:83]
    v_mfma_f32_16x16x32_bf16 v[84:87], a[84:87], a[24:27], v[84:87]
    s_waitcnt lgkmcnt(0)
    v_mfma_f32_16x16x32_bf16 v[80:83], a[88:91], a[28:31], v[80:83]
    v_mfma_f32_16x16x32_bf16 v[84:87], a[92:95], a[28:31], v[84:87]
    s_branch L_kvj2
L_kvV1:
    s_waitcnt vmcnt(24)
    s_waitcnt vmcnt(20)
    ds_read_b128 a[0:3], v151 offset:0
    ds_read_b64_tr_b16 a[32:33], v153 offset:0
    ds_read_b64_tr_b16 a[34:35], v153 offset:256
    ds_read_b64_tr_b16 a[36:37], v154 offset:0
    ds_read_b64_tr_b16 a[38:39], v154 offset:256
    ds_read_b128 a[4:7], v152 offset:0
    ds_read_b64_tr_b16 a[40:41], v153 offset:2048
    ds_read_b64_tr_b16 a[42:43], v153 offset:2304
    ds_read_b64_tr_b16 a[44:45], v154 offset:2048
    ds_read_b64_tr_b16 a[46:47], v154 offset:2304
    s_add_u32 m0, s64, 16384
    s_lshr_b32 s40, s39, 10
    buffer_load_dwordx4 v136, s[4:7], s40 offen offset:0 lds
    buffer_load_dwordx4 v137, s[4:7], s40 offen offset:1024 lds
    buffer_load_dwordx4 v138, s[4:7], s40 offen offset:2048 lds
    buffer_load_dwordx4 v139, s[4:7], s40 offen offset:3072 lds
    s_waitcnt lgkmcnt(5)
    v_mfma_f32_16x16x32_bf16 v[80:83], a[0:3], a[32:35], 0
    v_mfma_f32_16x16x32_bf16 v[84:87], a[0:3], a[36:39], 0
    s_waitcnt lgkmcnt(0)
    v_mfma_f32_16x16x32_bf16 v[80:83], a[4:7], a[40:43], v[80:83]
    v_mfma_f32_16x16x32_bf16 v[84:87], a[4:7], a[44:47], v[84:87]
    s_waitcnt vmcnt(22)
    s_waitcnt vmcnt(18)
    ds_read_b128 a[8:11], v151 offset:2048
    ds_read_b64_tr_b16 a[48:49], v153 offset:4096
    ds_read_b64_tr_b16 a[50:51], v153 offset:4352
    ds_read_b64_tr_b16 a[52:53], v154 offset:4096
    ds_read_b64_tr_b16 a[54:55], v154 offset:4352
    ds_read_b128 a[12:15], v152 offset:2048
    ds_read_b64_tr_b16 a[56:57], v153 offset:6144
    ds_read_b64_tr_b16 a[58:59], v153 offset:6400
    ds_read_b64_tr_b16 a[60:61], v154 offset:6144
    ds_read_b64_tr_b16 a[62:63], v154 offset:6400
    s_add_u32 s39, s39, s7
    s_add_u32 m0, s65, 40960
    s_and_b32 s39, s39, 0x1e0000
    buffer_load_dwordx4 v140, s[8:11], s39 offen offset:0 lds
    buffer_load_dwordx4 v141, s[8:11], s39 offen offset:1024 lds
    s_waitcnt lgkmcnt(5)
    v_mfma_f32_16x16x32_bf16 v[80:83], a[8:11], a[48:51], v[80:83]
    v_mfma_f32_16x16x32_bf16 v[84:87], a[8:11], a[52:55], v[84:87]
    s_waitcnt lgkmcnt(0)
    v_mfma_f32_16x16x32_bf16 v[80:83], a[12:15], a[56:59], v[80:83]
    v_mfma_f32_16x16x32_bf16 v[84:87], a[12:15], a[60:63], v[84:87]
    s_waitcnt vmcnt(16)
    s_waitcnt vmcnt(12)
    ds_read_b128 a[16:19], v151 offset:4096
    ds_read_b64_tr_b16 a[64:65], v153 offset:8192
    ds_read_b64_tr_b16 a[66:67], v153 offset:8448
    ds_read_b64_tr_b16 a[68:69], v154 offset:8192
    ds_read_b64_tr_b16 a[70:71], v154 offset:8448
    ds_read_b128 a[20:23], v152 offset:4096
    ds_read_b64_tr_b16 a[72:73], v153 offset:10240
    ds_read_b64_tr_b16 a[74:75], v153 offset:10496
    ds_read_b64_tr_b16 a[76:77], v154 offset:10240
    ds_read_b64_tr_b16 a[78:79], v154 offset:10496
    s_add_u32 m0, s64, 20480
    s_lshr_b32 s40, s39, 10
    buffer_load_dwordx4 v136, s[4:7], s40 offen offset:0 lds
    buffer_load_dwordx4 v137, s[4:7], s40 offen offset:1024 lds
    buffer_load_dwordx4 v138, s[4:7], s40 offen offset:2048 lds
    buffer_load_dwordx4 v139, s[4:7], s40 offen offset:3072 lds
    s_waitcnt lgkmcnt(5)
    v_mfma_f32_16x16x32_bf16 v[80:83], a[16:19], a[64:67], v[80:83]
    v_mfma_f32_16x16x32_bf16 v[84:87], a[16:19], a[68:71], v[84:87]
    s_waitcnt lgkmcnt(0)
    v_mfma_f32_16x16x32_bf16 v[80:83], a[20:23], a[72:75], v[80:83]
    v_mfma_f32_16x16x32_bf16 v[84:87], a[20:23], a[76:79], v[84:87]
    s_waitcnt vmcnt(14)
    s_waitcnt vmcnt(10)
    ds_read_b128 a[24:27], v151 offset:6144
    ds_read_b64_tr_b16 a[80:81], v153 offset:12288
    ds_read_b64_tr_b16 a[82:83], v153 offset:12544
    ds_read_b64_tr_b16 a[84:85], v154 offset:12288
    ds_read_b64_tr_b16 a[86:87], v154 offset:12544
    ds_read_b128 a[28:31], v152 offset:6144
    ds_read_b64_tr_b16 a[88:89], v153 offset:14336
    ds_read_b64_tr_b16 a[90:91], v153 offset:14592
    ds_read_b64_tr_b16 a[92:93], v154 offset:14336
    ds_read_b64_tr_b16 a[94:95], v154 offset:14592
    s_waitcnt lgkmcnt(5)
    v_mfma_f32_16x16x32_bf16 v[80:83], a[24:27], a[80:83], v[80:83]
    v_mfma_f32_16x16x32_bf16 v[84:87], a[24:27], a[84:87], v[84:87]
    s_waitcnt lgkmcnt(0)
    v_mfma_f32_16x16x32_bf16 v[80:83], a[28:31], a[88:91], v[80:83]
    v_mfma_f32_16x16x32_bf16 v[84:87], a[28:31], a[92:95], v[84:87]
L_kvj2:
    s_add_u32 s39, s39, s7
    s_and_b32 s39, s39, 0x1e0000
    s_add_u32 m0, s64, 0
    s_lshr_b32 s40, s39, 10
    buffer_load_dwordx4 v136, s[4:7], s40 offen offset:0 lds
    buffer_load_dwordx4 v137, s[4:7], s40 offen offset:1024 lds
    buffer_load_dwordx4 v138, s[4:7], s40 offen offset:2048 lds
    buffer_load_dwordx4 v139, s[4:7], s40 offen offset:3072 lds
    s_nop 7
    ds_write_b128 v45, v[80:83] offset:0
    ds_write_b128 v45, v[84:87] offset:1024
    s_waitcnt lgkmcnt(0)
    s_barrier
    s_add_u32 m0, s65, 0
    s_nop 0
    buffer_load_dwordx4 v140, s[8:11], s39 offen offset:0 lds
    buffer_load_dwordx4 v141, s[8:11], s39 offen offset:1024 lds
    s_add_u32 s39, s39, s7
    s_add_u32 m0, s65, 8192
    s_and_b32 s39, s39, 0x1e0000
    buffer_load_dwordx4 v140, s[8:11], s39 offen offset:0 lds
    buffer_load_dwordx4 v141, s[8:11], s39 offen offset:1024 lds
    s_add_u32 m0, s64, 4096
    s_lshr_b32 s40, s39, 10
    buffer_load_dwordx4 v136, s[4:7], s40 offen offset:0 lds
L_pad0:
    s_cbranch_execz L_pad1
    buffer_load_dwordx4 v137, s[4:7], s40 offen offset:1024 lds
    buffer_load_dwordx4 v138, s[4:7], s40 offen offset:2048 lds
    buffer_load_dwordx4 v139, s[4:7], s40 offen offset:3072 lds
    s_lshr_b32 s3, s3, 1
    s_mul_i32 s3, s3, 0x9e3779b1
    s_add_u32 s3, s3, 0x7f4a7c15
    s_lshl_b32 s3, s3, 1
    s_cmp_lg_u32 s38, 0
    s_cbranch_scc1 L_nored3
    ds_read_b128 v[224:227], v156 offset:0
    ds_read_b128 v[228:231], v156 offset:256
    ds_read_b128 v[232:235], v156 offset:2048
    ds_read_b128 v[236:239], v156 offset:2304
    ds_read_b128 v[240:243], v156 offset:4096
    ds_read_b128 v[244:247], v156 offset:4352
    ds_read_b128 v[248:251], v156 offset:6144
    ds_read_b128 v[252:255], v156 offset:6400
    s_waitcnt lgkmcnt(4)
    v_add_f32 v224, v224, v232
    v_add_f32 v225, v225, v233
    v_add_f32 v226, v226, v234
    v_add_f32 v227, v227, v235
    v_add_f32 v228, v228, v236
    v_add_f32 v229, v229, v237
    v_add_f32 v230, v230, v238
    v_add_f32 v231, v231, v239
    s_waitcnt lgkmcnt(2)
    v_add_f32 v224, v224, v240
    v_add_f32 v225, v225, v241
    v_add_f32 v226, v226, v242
    v_add_f32 v227, v227, v243
    v_add_f32 v228, v228, v244
    v_add_f32 v229, v229, v245
    v_add_f32 v230, v230, v246
    v_add_f32 v231, v231, v247
    s_waitcnt lgkmcnt(0)
    v_add_f32 v224, v224, v248
    v_add_f32 v225, v225, v249
    v_add_f32 v226, v226, v250
    v_add_f32 v227, v227, v251
    v_add_f32 v228, v228, v252
    v_add_f32 v229, v229, v253
    v_add_f32 v230, v230, v254
    v_add_f32 v231, v231, v255
    v_mul_f32 v224, s66, v224
    v_mul_f32 v225, s66, v225
    v_mul_f32 v226, s66, v226
    v_mul_f32 v227, s66, v227
    v_mul_f32 v228, s66, v228
    v_mul_f32 v229, s66, v229
    v_mul_f32 v230, s66, v230
    v_mul_f32 v231, s66, v231
    v_cvt_pk_bf16_f32 v232, v224, v225
    v_cvt_pk_bf16_f32 v233, v226, v227
    v_cvt_pk_bf16_f32 v234, v228, v229
    v_cvt_pk_bf16_f32 v235, v230, v231
L_nored3:
    buffer_store_dwordx4 v[232:235], v157, s[28:31], 0 offen sc1
    s_cmp_lg_u32 s38, 0
    s_cbranch_scc1 L_noguard4
    v_and_b32 v224, 0x7fffffff, v224
    v_and_b32 v225, 0x7fffffff, v225
    v_and_b32 v226, 0x7fffffff, v226
    v_and_b32 v227, 0x7fffffff, v227
    v_and_b32 v228, 0x7fffffff, v228
    v_and_b32 v229, 0x7fffffff, v229
    v_and_b32 v230, 0x7fffffff, v230
    v_and_b32 v231, 0x7fffffff, v231
    v_max3_u32 v1, v224, v225, v226
    v_max3_u32 v1, v1, v227, v228
    v_max3_u32 v1, v1, v229, v230
    v_max_u32 v1, v1, v231
    v_cmp_lt_u32 vcc, 0x53800000, v1
    s_cmp_lg_u64 vcc, 0
    s_cselect_b32 s44, 1, 0
L_noguard4:
    s_add_u32 s12, s62, s67
    s_addc_u32 s13, s63, 0
    s_movk_i32 s14, 4096
    s_waitcnt vmcnt(19)
    s_barrier
    s_add_u32 s39, s39, s7
    s_add_u32 m0, s65, 16384
    s_and_b32 s39, s39, 0x1e0000
    buffer_load_dwordx4 v140, s[8:11], s39 offen offset:0 lds
    ds_read_b128 v[160:163], v142 offset:16384
    ds_read_b128 v[164:167], v142 offset:18432
    ds_read_b64_tr_b16 v[192:193], v144 offset:32768
    ds_read_b64_tr_b16 v[194:195], v144 offset:33280
    ds_read_b64_tr_b16 v[196:197], v145 offset:32768
    ds_read_b64_tr_b16 v[198:199], v145 offset:33280
    buffer_load_dwordx4 v141, s[8:11], s39 offen offset:1024 lds
    ds_read_b64_tr_b16 v[200:201], v146 offset:32768
    ds_read_b64_tr_b16 v[202:203], v146 offset:33280
    ds_read_b64_tr_b16 v[204:205], v147 offset:32768
    ds_read_b64_tr_b16 v[206:207], v147 offset:33280
    ds_read_b128 v[168:171], v143 offset:16384
    ds_read_b128 v[172:175], v143 offset:18432
    ds_read_b64_tr_b16 v[208:209], v144 offset:36864
    s_add_u32 m0, s64, 8192
    s_lshr_b32 s40, s39, 10
    buffer_load_dwordx4 v136, s[4:7], s40 offen offset:0 lds
    ds_read_b64_tr_b16 v[210:211], v144 offset:37376
    ds_read_b64_tr_b16 v[212:213], v145 offset:36864
    ds_read_b64_tr_b16 v[214:215], v145 offset:37376
    ds_read_b64_tr_b16 v[216:217], v146 offset:36864
    ds_read_b64_tr_b16 v[218:219], v146 offset:37376
    ds_read_b64_tr_b16 v[220:221], v147 offset:36864
    ds_read_b64_tr_b16 v[222:223], v147 offset:37376
    buffer_load_dwordx4 v137, s[4:7], s40 offen offset:1024 lds
    buffer_load_dwordx4 v138, s[4:7], s40 offen offset:2048 lds
    s_waitcnt vmcnt(18) lgkmcnt(0)
    s_barrier
    v_mfma_f32_16x16x32_bf16 v[48:51], v[192:195], v[160:163], 0
    buffer_load_dwordx4 v139, s[4:7], s40 offen offset:3072 lds
    ds_read_b128 v[176:179], v142 offset:20480
    v_mfma_f32_16x16x32_bf16 v[52:55], v[192:195], v[164:167], 0
    ds_read_b128 v[180:183], v142 offset:22528
    ds_read_b64_tr_b16 v[224:225], v144 offset:40960
    v_mfma_f32_16x16x32_bf16 v[56:59], v[196:199], v[160:163], 0
    ds_read_b64_tr_b16 v[226:227], v144 offset:41472
    ds_read_b64_tr_b16 v[228:229], v145 offset:40960
    v_mfma_f32_16x16x32_bf16 v[60:63], v[196:199], v[164:167], 0
    ds_read_b64_tr_b16 v[230:231], v145 offset:41472
    s_add_u32 s39, s39, s7
    v_mfma_f32_16x16x32_bf16 v[64:67], v[200:203], v[160:163], 0
    s_add_u32 m0, s65, 24576
    s_and_b32 s39, s39, 0x1e0000
    v_mfma_f32_16x16x32_bf16 v[68:71], v[200:203], v[164:167], 0
    buffer_load_dwordx4 v140, s[8:11], s39 offen offset:0 lds
    ds_read_b64_tr_b16 v[232:233], v146 offset:40960
    v_mfma_f32_16x16x32_bf16 v[72:75], v[204:207], v[160:163], 0
    ds_read_b64_tr_b16 v[234:235], v146 offset:41472
    ds_read_b64_tr_b16 v[236:237], v147 offset:40960
    v_mfma_f32_16x16x32_bf16 v[76:79], v[204:207], v[164:167], 0
    ds_read_b64_tr_b16 v[238:239], v147 offset:41472
    ds_read_b128 v[184:187], v143 offset:20480
    v_mfma_f32_16x16x32_bf16 v[48:51], v[208:211], v[168:171], v[48:51]
    ds_read_b128 v[188:191], v143 offset:22528
    ds_read_b64_tr_b16 v[240:241], v144 offset:45056
    v_mfma_f32_16x16x32_bf16 v[52:55], v[208:211], v[172:175], v[52:55]
    buffer_load_dwordx4 v141, s[8:11], s39 offen offset:1024 lds
    ds_read_b64_tr_b16 v[242:243], v144 offset:45568
    v_mfma_f32_16x16x32_bf16 v[56:59], v[212:215], v[168:171], v[56:59]
    ds_read_b64_tr_b16 v[244:245], v145 offset:45056
    ds_read_b64_tr_b16 v[246:247], v145 offset:45568
    v_mfma_f32_16x16x32_bf16 v[60:63], v[212:215], v[172:175], v[60:63]
    ds_read_b64_tr_b16 v[248:249], v146 offset:45056
    ds_read_b64_tr_b16 v[250:251], v146 offset:45568
    v_mfma_f32_16x16x32_bf16 v[64:67], v[216:219], v[168:171], v[64:67]
    ds_read_b64_tr_b16 v[252:253], v147 offset:45056
    ds_read_b64_tr_b16 v[254:255], v147 offset:45568
    v_mfma_f32_16x16x32_bf16 v[68:71], v[216:219], v[172:175], v[68:71]
    s_add_u32 m0, s64, 12288
    s_lshr_b32 s40, s39, 10
    v_mfma_f32_16x16x32_bf16 v[72:75], v[220:223], v[168:171], v[72:75]
    buffer_load_dwordx4 v136, s[4:7], s40 offen offset:0 lds
    buffer_load_dwordx4 v137, s[4:7], s40 offen offset:1024 lds
    v_mfma_f32_16x16x32_bf16 v[76:79], v[220:223], v[172:175], v[76:79]
    s_waitcnt vmcnt(17) lgkmcnt(0)
    s_barrier
    v_mfma_f32_16x16x32_bf16 v[48:51], v[224:227], v[176:179], v[48:51]
    buffer_load_dwordx4 v138, s[4:7], s40 offen offset:2048 lds
    ds_read_b128 v[160:163], v142 offset:0
    v_mfma_f32_16x16x32_bf16 v[52:55], v[224:227], v[180:183], v[52:55]
    ds_read_b128 v[164:167], v142 offset:2048
    ds_read_b64_tr_b16 v[192:193], v144 offset:0
    v_mfma_f32_16x16x32_bf16 v[56:59], v[228:231], v[176:179], v[56:59]
    ds_read_b64_tr_b16 v[194:195], v144 offset:512
    buffer_load_dwordx4 v139, s[4:7], s40 offen offset:3072 lds
    v_mfma_f32_16x16x32_bf16 v[60:63], v[228:231], v[180:183], v[60:63]
    ds_read_b64_tr_b16 v[196:197], v145 offset:0
    ds_read_b64_tr_b16 v[198:199], v145 offset:512
    v_mfma_f32_16x16x32_bf16 v[64:67], v[232:235], v[176:179], v[64:67]
    ds_read_b64_tr_b16 v[200:201], v146 offset:0
    ds_read_b64_tr_b16 v[202:203], v146 offset:512
    v_mfma_f32_16x16x32_bf16 v[68:71], v[232:235], v[180:183], v[68:71]
    ds_read_b64_tr_b16 v[204:205], v147 offset:0
    s_add_u32 s39, s39, s7
    v_mfma_f32_16x16x32_bf16 v[72:75], v[236:239], v[176:179], v[72:75]
    s_add_u32 m0, s65, 32768
    s_and_b32 s39, s39, 0x1e0000
    v_mfma_f32_16x16x32_bf16 v[76:79], v[236:239], v[180:183], v[76:79]
    buffer_load_dwordx4 v140, s[8:11], s39 offen offset:0 lds
    ds_read_b64_tr_b16 v[206:207], v147 offset:512
    v_mfma_f32_16x16x32_bf16 v[48:51], v[240:243], v[184:187], v[48:51]
    ds_read_b128 v[168:171], v143 offset:0
    ds_read_b128 v[172:175], v143 offset:2048
    v_mfma_f32_16x16x32_bf16 v[52:55], v[240:243], v[188:191], v[52:55]
    ds_read_b64_tr_b16 v[208:209], v144 offset:4096
    buffer_load_dwordx4 v141, s[8:11], s39 offen offset:1024 lds
    v_mfma_f32_16x16x32_bf16 v[56:59], v[244:247], v[184:187], v[56:59]
    ds_read_b64_tr_b16 v[210:211], v144 offset:4608
    ds_read_b64_tr_b16 v[212:213], v145 offset:4096
    v_mfma_f32_16x16x32_bf16 v[60:63], v[244:247], v[188:191], v[60:63]
    ds_read_b64_tr_b16 v[214:215], v145 offset:4608
    ds_read_b64_tr_b16 v[216:217], v146 offset:4096
    v_mfma_f32_16x16x32_bf16 v[64:67], v[248:251], v[184:187], v[64:67]
    ds_read_b64_tr_b16 v[218:219], v146 offset:4608
    s_add_u32 m0, s64, 16384
    v_mfma_f32_16x16x32_bf16 v[68:71], v[248:251], v[188:191], v[68:71]
    s_lshr_b32 s40, s39, 10
    buffer_load_dwordx4 v136, s[4:7], s40 offen offset:0 lds
    v_mfma_f32_16x16x32_bf16 v[72:75], v[252:255], v[184:187], v[72:75]
    ds_read_b64_tr_b16 v[220:221], v147 offset:4096
    ds_read_b64_tr_b16 v[222:223], v147 offset:4608
    v_mfma_f32_16x16x32_bf16 v[76:79], v[252:255], v[188:191], v[76:79]
    buffer_load_dwordx4 v137, s[4:7], s40 offen offset:1024 lds
    s_or_b32 s41, s3, s44
    v_mov_b32 v1, s41
    v_mov_b32 v3, s3
    s_waitcnt vmcnt(16)
    buffer_store_dword v1, v2, s[24:27], 0 offen sc1
    s_waitcnt lgkmcnt(0)
    s_barrier
    v_mfma_f32_16x16x32_bf16 v[48:51], v[192:195], v[160:163], v[48:51]
    buffer_load_dwordx4 v138, s[4:7], s40 offen offset:2048 lds
    ds_read_b128 v[176:179], v142 offset:4096
    v_mfma_f32_16x16x32_bf16 v[52:55], v[192:195], v[164:167], v[52:55]
    ds_read_b128 v[180:183], v142 offset:6144
    ds_read_b64_tr_b16 v[224:225], v144 offset:8192
    v_mfma_f32_16x16x32_bf16 v[56:59], v[196:199], v[160:163], v[56:59]
    ds_read_b64_tr_b16 v[226:227], v144 offset:8704
    ds_read_b64_tr_b16 v[228:229], v145 offset:8192
    v_mfma_f32_16x16x32_bf16 v[60:63], v[196:199], v[164:167], v[60:63]
    ds_read_b64_tr_b16 v[230:231], v145 offset:8704
    buffer_load_dwordx4 v139, s[4:7], s40 offen offset:3072 lds
    v_mfma_f32_16x16x32_bf16 v[64:67], v[200:203], v[160:163], v[64:67]
    ds_read_b64_tr_b16 v[232:233], v146 offset:8192
    ds_read_b64_tr_b16 v[234:235], v146 offset:8704
    v_mfma_f32_16x16x32_bf16 v[68:71], v[200:203], v[164:167], v[68:71]
    ds_read_b64_tr_b16 v[236:237], v147 offset:8192
    ds_read_b64_tr_b16 v[238:239], v147 offset:8704
    v_mfma_f32_16x16x32_bf16 v[72:75], v[204:207], v[160:163], v[72:75]
    ds_read_b128 v[184:187], v143 offset:4096
    ds_read_b128 v[188:191], v143 offset:6144
    v_mfma_f32_16x16x32_bf16 v[76:79], v[204:207], v[164:167], v[76:79]
    ds_read_b64_tr_b16 v[240:241], v144 offset:12288
    s_add_u32 s39, s39, s7
    v_mfma_f32_16x16x32_bf16 v[48:51], v[208:211], v[168:171], v[48:51]
    s_add_u32 m0, s65, 40960
    s_and_b32 s39, s39, 0x1e0000
    v_mfma_f32_16x16x32_bf16 v[52:55], v[208:211], v[172:175], v[52:55]
    buffer_load_dwordx4 v140, s[8:11], s39 offen offset:0 lds
    ds_read_b64_tr_b16 v[242:243], v144 offset:12800
    v_mfma_f32_16x16x32_bf16 v[56:59], v[212:215], v[168:171], v[56:59]
    ds_read_b64_tr_b16 v[244:245], v145 offset:12288
    ds_read_b64_tr_b16 v[246:247], v145 offset:12800
    v_mfma_f32_16x16x32_bf16 v[60:63], v[212:215], v[172:175], v[60:63]
    ds_read_b64_tr_b16 v[248:249], v146 offset:12288
    ds_read_b64_tr_b16 v[250:251], v146 offset:12800
    v_mfma_f32_16x16x32_bf16 v[64:67], v[216:219], v[168:171], v[64:67]
    ds_read_b64_tr_b16 v[252:253], v147 offset:12288
    ds_read_b64_tr_b16 v[254:255], v147 offset:12800
    v_mfma_f32_16x16x32_bf16 v[68:71], v[216:219], v[172:175], v[68:71]
    buffer_load_dwordx4 v141, s[8:11], s39 offen offset:1024 lds
    s_add_u32 m0, s64, 20480
    v_mfma_f32_16x16x32_bf16 v[72:75], v[220:223], v[168:171], v[72:75]
    s_lshr_b32 s40, s39, 10
    buffer_load_dwordx4 v136, s[4:7], s40 offen offset:0 lds
    v_mfma_f32_16x16x32_bf16 v[76:79], v[220:223], v[172:175], v[76:79]
    s_waitcnt vmcnt(16) lgkmcnt(0)
    s_barrier
    v_mfma_f32_16x16x32_bf16 v[48:51], v[224:227], v[176:179], v[48:51]
    buffer_load_dwordx4 v137, s[4:7], s40 offen offset:1024 lds
    ds_read_b128 v[160:163], v142 offset:8192
    v_mfma_f32_16x16x32_bf16 v[52:55], v[224:227], v[180:183], v[52:55]
    ds_read_b128 v[164:167], v142 offset:10240
    ds_read_b64_tr_b16 v[192:193], v144 offset:16384
    v_mfma_f32_16x16x32_bf16 v[56:59], v[228:231], v[176:179], v[56:59]
    ds_read_b64_tr_b16 v[194:195], v144 offset:16896
    ds_read_b64_tr_b16 v[196:197], v145 offset:16384
    v_mfma_f32_16x16x32_bf16 v[60:63], v[228:231], v[180:183], v[60:63]
    ds_read_b64_tr_b16 v[198:199], v145 offset:16896
    buffer_load_dwordx4 v138, s[4:7], s40 offen offset:2048 lds
    v_mfma_f32_16x16x32_bf16 v[64:67], v[232:235], v[176:179], v[64:67]
    ds_read_b64_tr_b16 v[200:201], v146 offset:16384
    ds_read_b64_tr_b16 v[202:203], v146 offset:16896
    v_mfma_f32_16x16x32_bf16 v[68:71], v[232:235], v[180:183], v[68:71]
    ds_read_b64_tr_b16 v[204:205], v147 offset:16384
    ds_read_b64_tr_b16 v[206:207], v147 offset:16896
    v_mfma_f32_16x16x32_bf16 v[72:75], v[236:239], v[176:179], v[72:75]
    ds_read_b128 v[168:171], v143 offset:8192
    ds_read_b128 v[172:175], v143 offset:10240
    v_mfma_f32_16x16x32_bf16 v[76:79], v[236:239], v[180:183], v[76:79]
    ds_read_b64_tr_b16 v[208:209], v144 offset:20480
    buffer_load_dwordx4 v139, s[4:7], s40 offen offset:3072 lds
    v_mfma_f32_16x16x32_bf16 v[48:51], v[240:243], v[184:187], v[48:51]
    ds_read_b64_tr_b16 v[210:211], v144 offset:20992
    ds_read_b64_tr_b16 v[212:213], v145 offset:20480
    v_mfma_f32_16x16x32_bf16 v[52:55], v[240:243], v[188:191], v[52:55]
    ds_read_b64_tr_b16 v[214:215], v145 offset:20992
    ds_read_b64_tr_b16 v[216:217], v146 offset:20480
    v_mfma_f32_16x16x32_bf16 v[56:59], v[244:247], v[184:187], v[56:59]
    ds_read_b64_tr_b16 v[218:219], v146 offset:20992
    ds_read_b64_tr_b16 v[220:221], v147 offset:20480
    v_mfma_f32_16x16x32_bf16 v[60:63], v[244:247], v[188:191], v[60:63]
    ds_read_b64_tr_b16 v[222:223], v147 offset:20992
    s_add_u32 s39, s39, s7
    v_mfma_f32_16x16x32_bf16 v[64:67], v[248:251], v[184:187], v[64:67]
    s_add_u32 m0, s65, 0
    s_and_b32 s39, s39, 0x1e0000
    v_mfma_f32_16x16x32_bf16 v[68:71], v[248:251], v[188:191], v[68:71]
    buffer_load_dwordx4 v140, s[8:11], s39 offen offset:0 lds
    buffer_load_dwordx4 v141, s[8:11], s39 offen offset:1024 lds
    v_mfma_f32_16x16x32_bf16 v[72:75], v[252:255], v[184:187], v[72:75]
    v_mfma_f32_16x16x32_bf16 v[76:79], v[252:255], v[188:191], v[76:79]
    s_waitcnt vmcnt(15) lgkmcnt(0)
    s_barrier
    v_mfma_f32_16x16x32_bf16 v[48:51], v[192:195], v[160:163], v[48:51]
    s_add_u32 m0, s64, 0
    s_lshr_b32 s40, s39, 10
    v_mfma_f32_16x16x32_bf16 v[52:55], v[192:195], v[164:167], v[52:55]
    buffer_load_dwordx4 v136, s[4:7], s40 offen offset:0 lds
    ds_read_b128 v[176:179], v142 offset:12288
    v_mfma_f32_16x16x32_bf16 v[56:59], v[196:199], v[160:163], v[56:59]
    ds_read_b128 v[180:183], v142 offset:14336
    ds_read_b64_tr_b16 v[224:225], v144 offset:24576
    v_mfma_f32_16x16x32_bf16 v[60:63], v[196:199], v[164:167], v[60:63]
    ds_read_b64_tr_b16 v[226:227], v144 offset:25088
    ds_read_b64_tr_b16 v[228:229], v145 offset:24576
    v_mfma_f32_16x16x32_bf16 v[64:67], v[200:203], v[160:163], v[64:67]
    ds_read_b64_tr_b16 v[230:231], v145 offset:25088
    buffer_load_dwordx4 v137, s[4:7], s40 offen offset:1024 lds
    v_mfma_f32_16x16x32_bf16 v[68:71], v[200:203], v[164:167], v[68:71]
    ds_read_b64_tr_b16 v[232:233], v146 offset:24576
    ds_read_b64_tr_b16 v[234:235], v146 offset:25088
    v_mfma_f32_16x16x32_bf16 v[72:75], v[204:207], v[160:163], v[72:75]
    ds_read_b64_tr_b16 v[236:237], v147 offset:24576
    ds_read_b64_tr_b16 v[238:239], v147 offset:25088
    v_mfma_f32_16x16x32_bf16 v[76:79], v[204:207], v[164:167], v[76:79]
    ds_read_b128 v[184:187], v143 offset:12288
    ds_read_b128 v[188:191], v143 offset:14336
    v_mfma_f32_16x16x32_bf16 v[48:51], v[208:211], v[168:171], v[48:51]
    ds_read_b64_tr_b16 v[240:241], v144 offset:28672
    buffer_load_dwordx4 v138, s[4:7], s40 offen offset:2048 lds
    v_mfma_f32_16x16x32_bf16 v[52:55], v[208:211], v[172:175], v[52:55]
    ds_read_b64_tr_b16 v[242:243], v144 offset:29184
    ds_read_b64_tr_b16 v[244:245], v145 offset:28672
    v_mfma_f32_16x16x32_bf16 v[56:59], v[212:215], v[168:171], v[56:59]
    ds_read_b64_tr_b16 v[246:247], v145 offset:29184
    ds_read_b64_tr_b16 v[248:249], v146 offset:28672
    v_mfma_f32_16x16x32_bf16 v[60:63], v[212:215], v[172:175], v[60:63]
    ds_read_b64_tr_b16 v[250:251], v146 offset:29184
    ds_read_b64_tr_b16 v[252:253], v147 offset:28672
    v_mfma_f32_16x16x32_bf16 v[64:67], v[216:219], v[168:171], v[64:67]
    ds_read_b64_tr_b16 v[254:255], v147 offset:29184
    buffer_load_dwordx4 v139, s[4:7], s40 offen offset:3072 lds
    v_mfma_f32_16x16x32_bf16 v[68:71], v[216:219], v[172:175], v[68:71]
    s_add_u32 s39, s39, s7
    s_add_u32 m0, s65, 8192
    v_mfma_f32_16x16x32_bf16 v[72:75], v[220:223], v[168:171], v[72:75]
    s_and_b32 s39, s39, 0x1e0000
    buffer_load_dwordx4 v140, s[8:11], s39 offen offset:0 lds
    v_mfma_f32_16x16x32_bf16 v[76:79], v[220:223], v[172:175], v[76:79]
    s_waitcnt vmcnt(13) lgkmcnt(0)
    s_barrier
    v_mfma_f32_16x16x32_bf16 v[48:51], v[224:227], v[176:179], v[48:51]
    buffer_load_dwordx4 v141, s[8:11], s39 offen offset:1024 lds
    ds_read_b128 v[160:163], v142 offset:16384
    v_mfma_f32_16x16x32_bf16 v[52:55], v[224:227], v[180:183], v[52:55]
    ds_read_b128 v[164:167], v142 offset:18432
    ds_read_b64_tr_b16 v[192:193], v144 offset:32768
    v_mfma_f32_16x16x32_bf16 v[56:59], v[228:231], v[176:179], v[56:59]
    ds_read_b64_tr_b16 v[194:195], v144 offset:33280
    ds_read_b64_tr_b16 v[196:197], v145 offset:32768
    v_mfma_f32_16x16x32_bf16 v[60:63], v[228:231], v[180:183], v[60:63]
    ds_read_b64_tr_b16 v[198:199], v145 offset:33280
    s_add_u32 m0, s64, 4096
    v_mfma_f32_16x16x32_bf16 v[64:67], v[232:235], v[176:179], v[64:67]
    s_lshr_b32 s40, s39, 10
    buffer_load_dwordx4 v136, s[4:7], s40 offen offset:0 lds
    v_mfma_f32_16x16x32_bf16 v[68:71], v[232:235], v[180:183], v[68:71]
    ds_read_b64_tr_b16 v[200:201], v146 offset:32768
    ds_read_b64_tr_b16 v[202:203], v146 offset:33280
    v_mfma_f32_16x16x32_bf16 v[72:75], v[236:239], v[176:179], v[72:75]
    ds_read_b64_tr_b16 v[204:205], v147 offset:32768
    ds_read_b64_tr_b16 v[206:207], v147 offset:33280
    v_mfma_f32_16x16x32_bf16 v[76:79], v[236:239], v[180:183], v[76:79]
    ds_read_b128 v[168:171], v143 offset:16384
    ds_read_b128 v[172:175], v143 offset:18432
    v_mfma_f32_16x16x32_bf16 v[48:51], v[240:243], v[184:187], v[48:51]
    ds_read_b64_tr_b16 v[208:209], v144 offset:36864
    buffer_load_dwordx4 v137, s[4:7], s40 offen offset:1024 lds
    v_mfma_f32_16x16x32_bf16 v[52:55], v[240:243], v[188:191], v[52:55]
    ds_read_b64_tr_b16 v[210:211], v144 offset:37376
    ds_read_b64_tr_b16 v[212:213], v145 offset:36864
    v_mfma_f32_16x16x32_bf16 v[56:59], v[244:247], v[184:187], v[56:59]
    ds_read_b64_tr_b16 v[214:215], v145 offset:37376
    ds_read_b64_tr_b16 v[216:217], v146 offset:36864
    v_mfma_f32_16x16x32_bf16 v[60:63], v[244:247], v[188:191], v[60:63]
    ds_read_b64_tr_b16 v[218:219], v146 offset:37376
    ds_read_b64_tr_b16 v[220:221], v147 offset:36864
    v_mfma_f32_16x16x32_bf16 v[64:67], v[248:251], v[184:187], v[64:67]
    ds_read_b64_tr_b16 v[222:223], v147 offset:37376
    buffer_load_dwordx4 v138, s[4:7], s40 offen offset:2048 lds
    v_mfma_f32_16x16x32_bf16 v[68:71], v[248:251], v[188:191], v[68:71]
    buffer_load_dwordx4 v139, s[4:7], s40 offen offset:3072 lds
    v_mfma_f32_16x16x32_bf16 v[72:75], v[252:255], v[184:187], v[72:75]
    v_mfma_f32_16x16x32_bf16 v[76:79], v[252:255], v[188:191], v[76:79]
    s_waitcnt vmcnt(12) lgkmcnt(0)
    s_barrier
    v_mfma_f32_16x16x32_bf16 v[48:51], v[192:195], v[160:163], v[48:51]
    s_add_u32 s39, s39, s7
    s_add_u32 m0, s65, 16384
    v_mfma_f32_16x16x32_bf16 v[52:55], v[192:195], v[164:167], v[52:55]
    s_and_b32 s39, s39, 0x1e0000
    buffer_load_dwordx4 v140, s[8:11], s39 offen offset:0 lds
    v_mfma_f32_16x16x32_bf16 v[56:59], v[196:199], v[160:163], v[56:59]
    ds_read_b128 v[176:179], v142 offset:20480
    ds_read_b128 v[180:183], v142 offset:22528
    v_mfma_f32_16x16x32_bf16 v[60:63], v[196:199], v[164:167], v[60:63]
    ds_read_b64_tr_b16 v[224:225], v144 offset:40960
    ds_read_b64_tr_b16 v[226:227], v144 offset:41472
    v_mfma_f32_16x16x32_bf16 v[64:67], v[200:203], v[160:163], v[64:67]
    ds_read_b64_tr_b16 v[228:229], v145 offset:40960
    buffer_load_dwordx4 v141, s[8:11], s39 offen offset:1024 lds
    v_mfma_f32_16x16x32_bf16 v[68:71], v[200:203], v[164:167], v[68:71]
    ds_read_b64_tr_b16 v[230:231], v145 offset:41472
    ds_read_b64_tr_b16 v[232:233], v146 offset:40960
    v_mfma_f32_16x16x32_bf16 v[72:75], v[204:207], v[160:163], v[72:75]
    ds_read_b64_tr_b16 v[234:235], v146 offset:41472
    ds_read_b64_tr_b16 v[236:237], v147 offset:40960
    v_mfma_f32_16x16x32_bf16 v[76:79], v[204:207], v[164:167], v[76:79]
    ds_read_b64_tr_b16 v[238:239], v147 offset:41472
    s_add_u32 m0, s64, 8192
    v_mfma_f32_16x16x32_bf16 v[48:51], v[208:211], v[168:171], v[48:51]
    s_lshr_b32 s40, s39, 10
    buffer_load_dwordx4 v136, s[4:7], s40 offen offset:0 lds
    v_mfma_f32_16x16x32_bf16 v[52:55], v[208:211], v[172:175], v[52:55]
    ds_read_b128 v[184:187], v143 offset:20480
    ds_read_b128 v[188:191], v143 offset:22528
    v_mfma_f32_16x16x32_bf16 v[56:59], v[212:215], v[168:171], v[56:59]
    ds_read_b64_tr_b16 v[240:241], v144 offset:45056
    ds_read_b64_tr_b16 v[242:243], v144 offset:45568
    v_mfma_f32_16x16x32_bf16 v[60:63], v[212:215], v[172:175], v[60:63]
    ds_read_b64_tr_b16 v[244:245], v145 offset:45056
    ds_read_b64_tr_b16 v[246:247], v145 offset:45568
    v_mfma_f32_16x16x32_bf16 v[64:67], v[216:219], v[168:171], v[64:67]
    buffer_load_dwordx4 v137, s[4:7], s40 offen offset:1024 lds
    ds_read_b64_tr_b16 v[248:249], v146 offset:45056
    v_mfma_f32_16x16x32_bf16 v[68:71], v[216:219], v[172:175], v[68:71]
    ds_read_b64_tr_b16 v[250:251], v146 offset:45568
    ds_read_b64_tr_b16 v[252:253], v147 offset:45056
    v_mfma_f32_16x16x32_bf16 v[72:75], v[220:223], v[168:171], v[72:75]
    ds_read_b64_tr_b16 v[254:255], v147 offset:45568
    buffer_load_dwordx4 v138, s[4:7], s40 offen offset:2048 lds
    v_mfma_f32_16x16x32_bf16 v[76:79], v[220:223], v[172:175], v[76:79]
    buffer_load_dwordx4 v139, s[4:7], s40 offen offset:3072 lds
    s_waitcnt vmcnt(12) lgkmcnt(0)
    s_barrier
    v_mfma_f32_16x16x32_bf16 v[48:51], v[224:227], v[176:179], v[48:51]
    s_lshl_b32 s43, s38, 10
    buffer_load_dword v38, v37, s[24:27], s43 offen sc1
    ds_read_b128 v[160:163], v142 offset:0
    v_mfma_f32_16x16x32_bf16 v[52:55], v[224:227], v[180:183], v[52:55]
    ds_read_b128 v[164:167], v142 offset:2048
    ds_read_b64_tr_b16 v[192:193], v144 offset:0
    v_mfma_f32_16x16x32_bf16 v[56:59], v[228:231], v[176:179], v[56:59]
    ds_read_b64_tr_b16 v[194:195], v144 offset:512
    ds_read_b64_tr_b16 v[196:197], v145 offset:0
    v_mfma_f32_16x16x32_bf16 v[60:63], v[228:231], v[180:183], v[60:63]
    s_add_u32 s39, s39, s7
    s_add_u32 m0, s65, 24576
    v_mfma_f32_16x16x32_bf16 v[64:67], v[232:235], v[176:179], v[64:67]
    s_and_b32 s39, s39, 0x1e0000
    buffer_load_dwordx4 v140, s[8:11], s39 offen offset:0 lds
    v_mfma_f32_16x16x32_bf16 v[68:71], v[232:235], v[180:183], v[68:71]
    ds_read_b64_tr_b16 v[198:199], v145 offset:512
    ds_read_b64_tr_b16 v[200:201], v146 offset:0
    v_mfma_f32_16x16x32_bf16 v[72:75], v[236:239], v[176:179], v[72:75]
    ds_read_b64_tr_b16 v[202:203], v146 offset:512
    ds_read_b64_tr_b16 v[204:205], v147 offset:0
    v_mfma_f32_16x16x32_bf16 v[76:79], v[236:239], v[180:183], v[76:79]
    ds_read_b64_tr_b16 v[206:207], v147 offset:512
    buffer_load_dwordx4 v141, s[8:11], s39 offen offset:1024 lds
    v_mfma_f32_16x16x32_bf16 v[48:51], v[240:243], v[184:187], v[48:51]
    ds_read_b128 v[168:171], v143 offset:0
    ds_read_b128 v[172:175], v143 offset:2048
    v_mfma_f32_16x16x32_bf16 v[52:55], v[240:243], v[188:191], v[52:55]
    ds_read_b64_tr_b16 v[208:209], v144 offset:4096
    ds_read_b64_tr_b16 v[210:211], v144 offset:4608
    v_mfma_f32_16x16x32_bf16 v[56:59], v[244:247], v[184:187], v[56:59]
    ds_read_b64_tr_b16 v[212:213], v145 offset:4096
    ds_read_b64_tr_b16 v[214:215], v145 offset:4608
    v_mfma_f32_16x16x32_bf16 v[60:63], v[244:247], v[188:191], v[60:63]
    s_add_u32 m0, s64, 12288
    s_lshr_b32 s40, s39, 10
    v_mfma_f32_16x16x32_bf16 v[64:67], v[248:251], v[184:187], v[64:67]
    buffer_load_dwordx4 v136, s[4:7], s40 offen offset:0 lds
    ds_read_b64_tr_b16 v[216:217], v146 offset:4096
    v_mfma_f32_16x16x32_bf16 v[68:71], v[248:251], v[188:191], v[68:71]
    ds_read_b64_tr_b16 v[218:219], v146 offset:4608
    ds_read_b64_tr_b16 v[220:221], v147 offset:4096
    v_mfma_f32_16x16x32_bf16 v[72:75], v[252:255], v[184:187], v[72:75]
    ds_read_b64_tr_b16 v[222:223], v147 offset:4608
    buffer_load_dwordx4 v137, s[4:7], s40 offen offset:1024 lds
    v_mfma_f32_16x16x32_bf16 v[76:79], v[252:255], v[188:191], v[76:79]
    buffer_load_dwordx4 v138, s[4:7], s40 offen offset:2048 lds
    s_waitcnt vmcnt(12) lgkmcnt(0)
    s_barrier
    v_mfma_f32_16x16x32_bf16 v[48:51], v[192:195], v[160:163], v[48:51]
    buffer_load_dwordx4 v139, s[4:7], s40 offen offset:3072 lds
    ds_read_b128 v[176:179], v142 offset:4096
    v_mfma_f32_16x16x32_bf16 v[52:55], v[192:195], v[164:167], v[52:55]
    ds_read_b128 v[180:183], v142 offset:6144
    ds_read_b64_tr_b16 v[224:225], v144 offset:8192
    v_mfma_f32_16x16x32_bf16 v[56:59], v[196:199], v[160:163], v[56:59]
    ds_read_b64_tr_b16 v[226:227], v144 offset:8704
    ds_read_b64_tr_b16 v[228:229], v145 offset:8192
    v_mfma_f32_16x16x32_bf16 v[60:63], v[196:199], v[164:167], v[60:63]
    ds_read_b64_tr_b16 v[230:231], v145 offset:8704
    s_add_u32 s39, s39, s7
    v_mfma_f32_16x16x32_bf16 v[64:67], v[200:203], v[160:163], v[64:67]
    s_add_u32 m0, s65, 32768
    s_and_b32 s39, s39, 0x1e0000
    v_mfma_f32_16x16x32_bf16 v[68:71], v[200:203], v[164:167], v[68:71]
    buffer_load_dwordx4 v140, s[8:11], s39 offen offset:0 lds
    ds_read_b64_tr_b16 v[232:233], v146 offset:8192
    v_mfma_f32_16x16x32_bf16 v[72:75], v[204:207], v[160:163], v[72:75]
    ds_read_b64_tr_b16 v[234:235], v146 offset:8704
    ds_read_b64_tr_b16 v[236:237], v147 offset:8192
    v_mfma_f32_16x16x32_bf16 v[76:79], v[204:207], v[164:167], v[76:79]
    ds_read_b64_tr_b16 v[238:239], v147 offset:8704
    ds_read_b128 v[184:187], v143 offset:4096
    v_mfma_f32_16x16x32_bf16 v[48:51], v[208:211], v[168:171], v[48:51]
    ds_read_b128 v[188:191], v143 offset:6144
    ds_read_b64_tr_b16 v[240:241], v144 offset:12288
    v_mfma_f32_16x16x32_bf16 v[52:55], v[208:211], v[172:175], v[52:55]
    buffer_load_dwordx4 v141, s[8:11], s39 offen offset:1024 lds
    ds_read_b64_tr_b16 v[242:243], v144 offset:12800
    v_mfma_f32_16x16x32_bf16 v[56:59], v[212:215], v[168:171], v[56:59]
    ds_read_b64_tr_b16 v[244:245], v145 offset:12288
    ds_read_b64_tr_b16 v[246:247], v145 offset:12800
    v_mfma_f32_16x16x32_bf16 v[60:63], v[212:215], v[172:175], v[60:63]
    ds_read_b64_tr_b16 v[248:249], v146 offset:12288
    ds_read_b64_tr_b16 v[250:251], v146 offset:12800
    v_mfma_f32_16x16x32_bf16 v[64:67], v[216:219], v[168:171], v[64:67]
    ds_read_b64_tr_b16 v[252:253], v147 offset:12288
    ds_read_b64_tr_b16 v[254:255], v147 offset:12800
    v_mfma_f32_16x16x32_bf16 v[68:71], v[216:219], v[172:175], v[68:71]
    s_add_u32 m0, s64, 16384
    s_lshr_b32 s40, s39, 10
    v_mfma_f32_16x16x32_bf16 v[72:75], v[220:223], v[168:171], v[72:75]
    buffer_load_dwordx4 v136, s[4:7], s40 offen offset:0 lds
    buffer_load_dwordx4 v137, s[4:7], s40 offen offset:1024 lds
    v_mfma_f32_16x16x32_bf16 v[76:79], v[220:223], v[172:175], v[76:79]
    s_waitcnt vmcnt(11) lgkmcnt(0)
    s_barrier
    v_mfma_f32_16x16x32_bf16 v[48:51], v[224:227], v[176:179], v[48:51]
    buffer_load_dwordx4 v138, s[4:7], s40 offen offset:2048 lds
    ds_read_b128 v[160:163], v142 offset:8192
    v_mfma_f32_16x16x32_bf16 v[52:55], v[224:227], v[180:183], v[52:55]
    ds_read_b128 v[164:167], v142 offset:10240
    ds_read_b64_tr_b16 v[192:193], v144 offset:16384
    v_mfma_f32_16x16x32_bf16 v[56:59], v[228:231], v[176:179], v[56:59]
    ds_read_b64_tr_b16 v[194:195], v144 offset:16896
    ds_read_b64_tr_b16 v[196:197], v145 offset:16384
    v_mfma_f32_16x16x32_bf16 v[60:63], v[228:231], v[180:183], v[60:63]
    ds_read_b64_tr_b16 v[198:199], v145 offset:16896
L_pad1:
    s_cbranch_execz L_padback
    buffer_load_dwordx4 v139, s[4:7], s40 offen offset:3072 lds
    v_mfma_f32_16x16x32_bf16 v[64:67], v[232:235], v[176:179], v[64:67]
    ds_read_b64_tr_b16 v[200:201], v146 offset:16384
    ds_read_b64_tr_b16 v[202:203], v146 offset:16896
    v_mfma_f32_16x16x32_bf16 v[68:71], v[232:235], v[180:183], v[68:71]
    ds_read_b64_tr_b16 v[204:205], v147 offset:16384
    ds_read_b64_tr_b16 v[206:207], v147 offset:16896
    v_mfma_f32_16x16x32_bf16 v[72:75], v[236:239], v[176:179], v[72:75]
    ds_read_b128 v[168:171], v143 offset:8192
    ds_read_b128 v[172:175], v143 offset:10240
    v_mfma_f32_16x16x32_bf16 v[76:79], v[236:239], v[180:183], v[76:79]
    ds_read_b64_tr_b16 v[208:209], v144 offset:20480
    s_add_u32 s39, s39, s7
    v_mfma_f32_16x16x32_bf16 v[48:51], v[240:243], v[184:187], v[48:51]
    s_add_u32 m0, s65, 40960
    s_and_b32 s39, s39, 0x1e0000
    v_mfma_f32_16x16x32_bf16 v[52:55], v[240:243], v[188:191], v[52:55]
    buffer_load_dwordx4 v140, s[8:11], s39 offen offset:0 lds
    ds_read_b64_tr_b16 v[210:211], v144 offset:20992
    v_mfma_f32_16x16x32_bf16 v[56:59], v[244:247], v[184:187], v[56:59]
    ds_read_b64_tr_b16 v[212:213], v145 offset:20480
    ds_read_b64_tr_b16 v[214:215], v145 offset:20992
    v_mfma_f32_16x16x32_bf16 v[60:63], v[244:247], v[188:191], v[60:63]
    ds_read_b64_tr_b16 v[216:217], v146 offset:20480
    ds_read_b64_tr_b16 v[218:219], v146 offset:20992
    v_mfma_f32_16x16x32_bf16 v[64:67], v[248:251], v[184:187], v[64:67]
    ds_read_b64_tr_b16 v[220:221], v147 offset:20480
    ds_read_b64_tr_b16 v[222:223], v147 offset:20992
    v_mfma_f32_16x16x32_bf16 v[68:71], v[248:251], v[188:191], v[68:71]
    buffer_load_dwordx4 v141, s[8:11], s39 offen offset:1024 lds
    s_add_u32 m0, s64, 20480
    v_mfma_f32_16x16x32_bf16 v[72:75], v[252:255], v[184:187], v[72:75]
    s_lshr_b32 s40, s39, 10
    buffer_load_dwordx4 v136, s[4:7], s40 offen offset:0 lds
    v_mfma_f32_16x16x32_bf16 v[76:79], v[252:255], v[188:191], v[76:79]
    s_waitcnt vmcnt(9) lgkmcnt(0)
    s_barrier
    v_mfma_f32_16x16x32_bf16 v[48:51], v[192:195], v[160:163], v[48:51]
    v_and_b32 v1, -2, v38
    v_cmp_ne_u32 vcc, s3, v1
    s_cmp_lg_u64 vcc, 0
    s_cbranch_scc1 L_repoll5
L_repollret6:
    ds_read_b128 v[176:179], v142 offset:12288
    v_mfma_f32_16x16x32_bf16 v[52:55], v[192:195], v[164:167], v[52:55]
    ds_read_b128 v[180:183], v142 offset:14336
    ds_read_b64_tr_b16 v[224:225], v144 offset:24576
    v_mfma_f32_16x16x32_bf16 v[56:59], v[196:199], v[160:163], v[56:59]
    ds_read_b64_tr_b16 v[226:227], v144 offset:25088
    ds_read_b64_tr_b16 v[228:229], v145 offset:24576
    v_mfma_f32_16x16x32_bf16 v[60:63], v[196:199], v[164:167], v[60:63]
    buffer_load_dwordx4 v137, s[4:7], s40 offen offset:1024 lds
    ds_read_b64_tr_b16 v[230:231], v145 offset:25088
    v_mfma_f32_16x16x32_bf16 v[64:67], v[200:203], v[160:163], v[64:67]
    ds_read_b64_tr_b16 v[232:233], v146 offset:24576
    ds_read_b64_tr_b16 v[234:235], v146 offset:25088
    v_mfma_f32_16x16x32_bf16 v[68:71], v[200:203], v[164:167], v[68:71]
    ds_read_b64_tr_b16 v[236:237], v147 offset:24576
    ds_read_b64_tr_b16 v[238:239], v147 offset:25088
    v_mfma_f32_16x16x32_bf16 v[72:75], v[204:207], v[160:163], v[72:75]
    buffer_load_dwordx4 v138, s[4:7], s40 offen offset:2048 lds
    ds_read_b128 v[184:187], v143 offset:12288
    v_mfma_f32_16x16x32_bf16 v[76:79], v[204:207], v[164:167], v[76:79]
    ds_read_b128 v[188:191], v143 offset:14336
    ds_read_b64_tr_b16 v[240:241], v144 offset:28672
    v_mfma_f32_16x16x32_bf16 v[48:51], v[208:211], v[168:171], v[48:51]
    ds_read_b64_tr_b16 v[242:243], v144 offset:29184
    ds_read_b64_tr_b16 v[244:245], v145 offset:28672
    v_mfma_f32_16x16x32_bf16 v[52:55], v[208:211], v[172:175], v[52:55]
    ds_read_b64_tr_b16 v[246:247], v145 offset:29184
    buffer_load_dwordx4 v139, s[4:7], s40 offen offset:3072 lds
    v_mfma_f32_16x16x32_bf16 v[56:59], v[212:215], v[168:171], v[56:59]
    ds_read_b64_tr_b16 v[248:249], v146 offset:28672
    ds_read_b64_tr_b16 v[250:251], v146 offset:29184
    v_mfma_f32_16x16x32_bf16 v[60:63], v[212:215], v[172:175], v[60:63]
    ds_read_b64_tr_b16 v[252:253], v147 offset:28672
    ds_read_b64_tr_b16 v[254:255], v147 offset:29184
    v_mfma_f32_16x16x32_bf16 v[64:67], v[216:219], v[168:171], v[64:67]
    s_add_u32 s39, s39, s7
    s_add_u32 m0, s65, 0
    v_mfma_f32_16x16x32_bf16 v[68:71], v[216:219], v[172:175], v[68:71]
    s_and_b32 s39, s39, 0x1e0000
    buffer_load_dwordx4 v140, s[8:11], s39 offen offset:0 lds
    v_mfma_f32_16x16x32_bf16 v[72:75], v[220:223], v[168:171], v[72:75]
    buffer_load_dwordx4 v141, s[8:11], s39 offen offset:1024 lds
    v_mfma_f32_16x16x32_bf16 v[76:79], v[220:223], v[172:175], v[76:79]
    s_waitcnt vmcnt(8) lgkmcnt(0)
    s_barrier
    v_mfma_f32_16x16x32_bf16 v[48:51], v[224:227], v[176:179], v[48:51]
    s_add_u32 m0, s64, 0
    s_lshr_b32 s40, s39, 10
    v_mfma_f32_16x16x32_bf16 v[52:55], v[224:227], v[180:183], v[52:55]
    buffer_load_dwordx4 v136, s[4:7], s40 offen offset:0 lds
    ds_read_b128 v[160:163], v142 offset:16384
    v_mfma_f32_16x16x32_bf16 v[56:59], v[228:231], v[176:179], v[56:59]
    ds_read_b128 v[164:167], v142 offset:18432
    ds_read_b64_tr_b16 v[192:193], v144 offset:32768
    v_mfma_f32_16x16x32_bf16 v[60:63], v[228:231], v[180:183], v[60:63]
    ds_read_b64_tr_b16 v[194:195], v144 offset:33280
    ds_read_b64_tr_b16 v[196:197], v145 offset:32768
    v_mfma_f32_16x16x32_bf16 v[64:67], v[232:235], v[176:179], v[64:67]
    buffer_load_dwordx4 v137, s[4:7], s40 offen offset:1024 lds
    ds_read_b64_tr_b16 v[198:199], v145 offset:33280
    v_mfma_f32_16x16x32_bf16 v[68:71], v[232:235], v[180:183], v[68:71]
    ds_read_b64_tr_b16 v[200:201], v146 offset:32768
    ds_read_b64_tr_b16 v[202:203], v146 offset:33280
    v_mfma_f32_16x16x32_bf16 v[72:75], v[236:239], v[176:179], v[72:75]
    ds_read_b64_tr_b16 v[204:205], v147 offset:32768
    ds_read_b64_tr_b16 v[206:207], v147 offset:33280
    v_mfma_f32_16x16x32_bf16 v[76:79], v[236:239], v[180:183], v[76:79]
    buffer_load_dwordx4 v138, s[4:7], s40 offen offset:2048 lds
    ds_read_b128 v[168:171], v143 offset:16384
    v_mfma_f32_16x16x32_bf16 v[48:51], v[240:243], v[184:187], v[48:51]
    ds_read_b128 v[172:175], v143 offset:18432
    ds_read_b64_tr_b16 v[208:209], v144 offset:36864
    v_mfma_f32_16x16x32_bf16 v[52:55], v[240:243], v[188:191], v[52:55]
    ds_read_b64_tr_b16 v[210:211], v144 offset:37376
    ds_read_b64_tr_b16 v[212:213], v145 offset:36864
    v_mfma_f32_16x16x32_bf16 v[56:59], v[244:247], v[184:187], v[56:59]
    ds_read_b64_tr_b16 v[214:215], v145 offset:37376
    buffer_load_dwordx4 v139, s[4:7], s40 offen offset:3072 lds
    v_mfma_f32_16x16x32_bf16 v[60:63], v[244:247], v[188:191], v[60:63]
    ds_read_b64_tr_b16 v[216:217], v146 offset:36864
    ds_read_b64_tr_b16 v[218:219], v146 offset:37376
    v_mfma_f32_16x16x32_bf16 v[64:67], v[248:251], v[184:187], v[64:67]
    ds_read_b64_tr_b16 v[220:221], v147 offset:36864
    ds_read_b64_tr_b16 v[222:223], v147 offset:37376
    v_mfma_f32_16x16x32_bf16 v[68:71], v[248:251], v[188:191], v[68:71]
    s_add_u32 s39, s39, s7
    s_add_u32 m0, s65, 8192
    v_mfma_f32_16x16x32_bf16 v[72:75], v[252:255], v[184:187], v[72:75]
    s_and_b32 s39, s39, 0x1e0000
    buffer_load_dwordx4 v140, s[8:11], s39 offen offset:0 lds
    v_mfma_f32_16x16x32_bf16 v[76:79], v[252:255], v[188:191], v[76:79]
    buffer_load_dwordx4 v141, s[8:11], s39 offen offset:1024 lds
    s_waitcnt vmcnt(8) lgkmcnt(0)
    s_barrier
    v_mfma_f32_16x16x32_bf16 v[48:51], v[192:195], v[160:163], v[48:51]
    s_add_u32 m0, s64, 4096
    s_lshr_b32 s40, s39, 10
    v_mfma_f32_16x16x32_bf16 v[52:55], v[192:195], v[164:167], v[52:55]
    buffer_load_dwordx4 v136, s[4:7], s40 offen offset:0 lds
    ds_read_b128 v[176:179], v142 offset:20480
    v_mfma_f32_16x16x32_bf16 v[56:59], v[196:199], v[160:163], v[56:59]
    ds_read_b128 v[180:183], v142 offset:22528
    ds_read_b64_tr_b16 v[224:225], v144 offset:40960
    v_mfma_f32_16x16x32_bf16 v[60:63], v[196:199], v[164:167], v[60:63]
    ds_read_b64_tr_b16 v[226:227], v144 offset:41472
    ds_read_b64_tr_b16 v[228:229], v145 offset:40960
    v_mfma_f32_16x16x32_bf16 v[64:67], v[200:203], v[160:163], v[64:67]
    ds_read_b64_tr_b16 v[230:231], v145 offset:41472
    ds_read_b64_tr_b16 v[232:233], v146 offset:40960
    v_mfma_f32_16x16x32_bf16 v[68:71], v[200:203], v[164:167], v[68:71]
    ds_read_b64_tr_b16 v[234:235], v146 offset:41472
    ds_read_b64_tr_b16 v[236:237], v147 offset:40960
    v_mfma_f32_16x16x32_bf16 v[72:75], v[204:207], v[160:163], v[72:75]
    buffer_load_dwordx4 v137, s[4:7], s40 offen offset:1024 lds
    ds_read_b64_tr_b16 v[238:239], v147 offset:41472
    v_mfma_f32_16x16x32_bf16 v[76:79], v[204:207], v[164:167], v[76:79]
    ds_read_b128 v[184:187], v143 offset:20480
    ds_read_b128 v[188:191], v143 offset:22528
    v_mfma_f32_16x16x32_bf16 v[48:51], v[208:211], v[168:171], v[48:51]
    ds_read_b64_tr_b16 v[240:241], v144 offset:45056
    ds_read_b64_tr_b16 v[242:243], v144 offset:45568
    v_mfma_f32_16x16x32_bf16 v[52:55], v[208:211], v[172:175], v[52:55]
    ds_read_b64_tr_b16 v[244:245], v145 offset:45056
    ds_read_b64_tr_b16 v[246:247], v145 offset:45568
    v_mfma_f32_16x16x32_bf16 v[56:59], v[212:215], v[168:171], v[56:59]
    ds_read_b64_tr_b16 v[248:249], v146 offset:45056
    ds_read_b64_tr_b16 v[250:251], v146 offset:45568
    v_mfma_f32_16x16x32_bf16 v[60:63], v[212:215], v[172:175], v[60:63]
    buffer_load_dwordx4 v138, s[4:7], s40 offen offset:2048 lds
    ds_read_b64_tr_b16 v[252:253], v147 offset:45056
    v_mfma_f32_16x16x32_bf16 v[64:67], v[216:219], v[168:171], v[64:67]
    ds_read_b64_tr_b16 v[254:255], v147 offset:45568
    buffer_load_dwordx4 v139, s[4:7], s40 offen offset:3072 lds
    v_mfma_f32_16x16x32_bf16 v[68:71], v[216:219], v[172:175], v[68:71]
    v_mfma_f32_16x16x32_bf16 v[72:75], v[220:223], v[168:171], v[72:75]
    v_mfma_f32_16x16x32_bf16 v[76:79], v[220:223], v[172:175], v[76:79]
    s_waitcnt vmcnt(6) lgkmcnt(0)
    s_barrier
    v_mfma_f32_16x16x32_bf16 v[48:51], v[224:227], v[176:179], v[48:51]
    v_and_b32 v1, -2, v38
    v_cmp_ne_u32 vcc, s3, v1
    s_cmp_lg_u64 vcc, 0
    s_cbranch_scc1 L_kv_retry7
L_kv_ok8:
    v_cmp_ne_u32 vcc, s3, v38
    s_cmp_lg_u64 vcc, 0
    s_cbranch_scc1 L_poison10
L_poisonret11:
    ds_read_b128 v[160:163], v142 offset:0
    v_mfma_f32_16x16x32_bf16 v[52:55], v[224:227], v[180:183], v[52:55]
    ds_read_b128 v[164:167], v142 offset:2048
    ds_read_b64_tr_b16 v[192:193], v144 offset:0
    v_mfma_f32_16x16x32_bf16 v[56:59], v[228:231], v[176:179], v[56:59]
    ds_read_b64_tr_b16 v[194:195], v144 offset:512
    buffer_load_dwordx4 a[0:3], v37, s[12:15], 0 offen offset:0 sc1
    v_mfma_f32_16x16x32_bf16 v[60:63], v[228:231], v[180:183], v[60:63]
    ds_read_b64_tr_b16 v[196:197], v145 offset:0
    ds_read_b64_tr_b16 v[198:199], v145 offset:512
    v_mfma_f32_16x16x32_bf16 v[64:67], v[232:235], v[176:179], v[64:67]
    ds_read_b64_tr_b16 v[200:201], v146 offset:0
    ds_read_b64_tr_b16 v[202:203], v146 offset:512
    v_mfma_f32_16x16x32_bf16 v[68:71], v[232:235], v[180:183], v[68:71]
    ds_read_b64_tr_b16 v[204:205], v147 offset:0
    buffer_load_dwordx4 a[4:7], v37, s[12:15], 0 offen offset:1024 sc1
    v_mfma_f32_16x16x32_bf16 v[72:75], v[236:239], v[176:179], v[72:75]
    ds_read_b64_tr_b16 v[206:207], v147 offset:512
    ds_read_b128 v[168:171], v143 offset:0
    v_mfma_f32_16x16x32_bf16 v[76:79], v[236:239], v[180:183], v[76:79]
    ds_read_b128 v[172:175], v143 offset:2048
    ds_read_b64_tr_b16 v[208:209], v144 offset:4096
    v_mfma_f32_16x16x32_bf16 v[48:51], v[240:243], v[184:187], v[48:51]
    buffer_load_dwordx4 a[8:11], v37, s[12:15], 0 offen offset:2048 sc1
    ds_read_b64_tr_b16 v[210:211], v144 offset:4608
    v_mfma_f32_16x16x32_bf16 v[52:55], v[240:243], v[188:191], v[52:55]
    ds_read_b64_tr_b16 v[212:213], v145 offset:4096
    ds_read_b64_tr_b16 v[214:215], v145 offset:4608
    v_mfma_f32_16x16x32_bf16 v[56:59], v[244:247], v[184:187], v[56:59]
    ds_read_b64_tr_b16 v[216:217], v146 offset:4096
    ds_read_b64_tr_b16 v[218:219], v146 offset:4608
    v_mfma_f32_16x16x32_bf16 v[60:63], v[244:247], v[188:191], v[60:63]
    buffer_load_dwordx4 a[12:15], v37, s[12:15], 0 offen offset:3072 sc1
    ds_read_b64_tr_b16 v[220:221], v147 offset:4096
    v_mfma_f32_16x16x32_bf16 v[64:67], v[248:251], v[184:187], v[64:67]
    ds_read_b64_tr_b16 v[222:223], v147 offset:4608
    s_add_u32 s12, s12, 4096
    s_addc_u32 s13, s13, 0
    buffer_load_dwordx4 a[16:19], v37, s[12:15], 0 offen offset:0 sc1
    v_mfma_f32_16x16x32_bf16 v[68:71], v[248:251], v[188:191], v[68:71]
    buffer_load_dwordx4 a[20:23], v37, s[12:15], 0 offen offset:1024 sc1
    v_mfma_f32_16x16x32_bf16 v[72:75], v[252:255], v[184:187], v[72:75]
    v_mfma_f32_16x16x32_bf16 v[76:79], v[252:255], v[188:191], v[76:79]
    s_waitcnt vmcnt(6) lgkmcnt(0)
    s_barrier
    v_mfma_f32_16x16x32_bf16 v[48:51], v[192:195], v[160:163], v[48:51]
    ds_read_b128 v[176:179], v142 offset:4096
    ds_read_b128 v[180:183], v142 offset:6144
    v_mfma_f32_16x16x32_bf16 v[52:55], v[192:195], v[164:167], v[52:55]
    ds_read_b64_tr_b16 v[224:225], v144 offset:8192
    ds_read_b64_tr_b16 v[226:227], v144 offset:8704
    v_mfma_f32_16x16x32_bf16 v[56:59], v[196:199], v[160:163], v[56:59]
    ds_read_b64_tr_b16 v[228:229], v145 offset:8192
    ds_read_b64_tr_b16 v[230:231], v145 offset:8704
    v_mfma_f32_16x16x32_bf16 v[60:63], v[196:199], v[164:167], v[60:63]
    ds_read_b128 v[184:187], v143 offset:4096
    ds_read_b128 v[188:191], v143 offset:6144
    v_mfma_f32_16x16x32_bf16 v[48:51], v[208:211], v[168:171], v[48:51]
    ds_read_b64_tr_b16 v[240:241], v144 offset:12288
    ds_read_b64_tr_b16 v[242:243], v144 offset:12800
    v_mfma_f32_16x16x32_bf16 v[52:55], v[208:211], v[172:175], v[52:55]
    ds_read_b64_tr_b16 v[244:245], v145 offset:12288
    ds_read_b64_tr_b16 v[246:247], v145 offset:12800
    v_mfma_f32_16x16x32_bf16 v[56:59], v[212:215], v[168:171], v[56:59]
    ds_read_b64_tr_b16 v[232:233], v146 offset:8192
    ds_read_b64_tr_b16 v[234:235], v146 offset:8704
    v_mfma_f32_16x16x32_bf16 v[60:63], v[212:215], v[172:175], v[60:63]
    ds_read_b64_tr_b16 v[236:237], v147 offset:8192
    ds_read_b64_tr_b16 v[238:239], v147 offset:8704
    s_waitcnt lgkmcnt(4)
    v_mfma_f32_16x16x32_bf16 v[48:51], v[224:227], v[176:179], v[48:51]
    v_mfma_f32_16x16x32_bf16 v[52:55], v[224:227], v[180:183], v[52:55]
    ds_read_b64_tr_b16 v[248:249], v146 offset:12288
    v_mfma_f32_16x16x32_bf16 v[56:59], v[228:231], v[176:179], v[56:59]
    ds_read_b64_tr_b16 v[250:251], v146 offset:12800
    v_mfma_f32_16x16x32_bf16 v[60:63], v[228:231], v[180:183], v[60:63]
    ds_read_b64_tr_b16 v[252:253], v147 offset:12288
    v_mfma_f32_16x16x32_bf16 v[48:51], v[240:243], v[184:187], v[48:51]
    v_mfma_f32_16x16x32_bf16 v[52:55], v[240:243], v[188:191], v[52:55]
    ds_read_b64_tr_b16 v[254:255], v147 offset:12800
    v_mfma_f32_16x16x32_bf16 v[56:59], v[244:247], v[184:187], v[56:59]
    buffer_load_dwordx4 a[24:27], v37, s[12:15], 0 offen offset:2048 sc1
    v_mfma_f32_16x16x32_bf16 v[60:63], v[244:247], v[188:191], v[60:63]
    buffer_load_dwordx4 a[28:31], v37, s[12:15], 0 offen offset:3072 sc1
    v_mfma_f32_16x16x32_bf16 v[64:67], v[200:203], v[160:163], v[64:67]
    v_mfma_f32_16x16x32_bf16 v[68:71], v[200:203], v[164:167], v[68:71]
    s_add_u32 s12, s12, 4096
    s_addc_u32 s13, s13, 0
    buffer_load_dwordx4 a[32:35], v37, s[12:15], 0 offen offset:0 sc1
    v_mfma_f32_16x16x32_bf16 v[72:75], v[204:207], v[160:163], v[72:75]
    v_mfma_f32_16x16x32_bf16 v[76:79], v[204:207], v[164:167], v[76:79]
    buffer_load_dwordx4 a[36:39], v37, s[12:15], 0 offen offset:1024 sc1
    v_mfma_f32_16x16x32_bf16 v[64:67], v[216:219], v[168:171], v[64:67]
    v_cvt_pk_bf16_f32 v48, v48, v49
    v_cvt_pk_bf16_f32 v49, v50, v51
    ds_write_b64 v36, v[48:49] offset:0
    v_mfma_f32_16x16x32_bf16 v[68:71], v[216:219], v[172:175], v[68:71]
    v_cvt_pk_bf16_f32 v52, v52, v53
    v_cvt_pk_bf16_f32 v53, v54, v55
    ds_write_b64 v36, v[52:53] offset:256
    v_cvt_pk_bf16_f32 v56, v56, v57
    v_mfma_f32_16x16x32_bf16 v[72:75], v[220:223], v[168:171], v[72:75]
    v_cvt_pk_bf16_f32 v57, v58, v59
    ds_write_b64 v36, v[56:57] offset:1024
    v_cvt_pk_bf16_f32 v60, v60, v61
    v_mfma_f32_16x16x32_bf16 v[76:79], v[220:223], v[172:175], v[76:79]
    v_cvt_pk_bf16_f32 v61, v62, v63
    ds_write_b64 v36, v[60:61] offset:1280
    ds_read_b128 v[136:139], v45 offset:0
    ds_read_b128 v[140:143], v45 offset:1024
    s_waitcnt lgkmcnt(6)
    v_mfma_f32_16x16x32_bf16 v[64:67], v[232:235], v[176:179], v[64:67]
    v_mfma_f32_16x16x32_bf16 v[68:71], v[232:235], v[180:183], v[68:71]
    v_mfma_f32_16x16x32_bf16 v[72:75], v[236:239], v[176:179], v[72:75]
    v_mfma_f32_16x16x32_bf16 v[76:79], v[236:239], v[180:183], v[76:79]
    buffer_load_dwordx4 a[40:43], v37, s[12:15], 0 offen offset:2048 sc1
    v_mfma_f32_16x16x32_bf16 v[64:67], v[248:251], v[184:187], v[64:67]
    v_mfma_f32_16x16x32_bf16 v[68:71], v[248:251], v[188:191], v[68:71]
    v_mfma_f32_16x16x32_bf16 v[72:75], v[252:255], v[184:187], v[72:75]
    v_mfma_f32_16x16x32_bf16 v[76:79], v[252:255], v[188:191], v[76:79]
    buffer_load_dwordx4 a[44:47], v37, s[12:15], 0 offen offset:3072 sc1
    s_waitcnt vmcnt(10) lgkmcnt(0)
    v_mfma_f32_32x32x16_bf16 v[80:95], a[0:3], v[136:139], 0
    v_mfma_f32_32x32x16_bf16 v[80:95], a[4:7], v[140:143], v[80:95]
    s_nop 1
    v_cvt_pk_bf16_f32 v64, v64, v65
    v_cvt_pk_bf16_f32 v65, v66, v67
    ds_write_b64 v36, v[64:65] offset:8192
    v_cvt_pk_bf16_f32 v68, v68, v69
    v_cvt_pk_bf16_f32 v69, v70, v71
    ds_write_b64 v36, v[68:69] offset:8448
    v_cvt_pk_bf16_f32 v72, v72, v73
    v_cvt_pk_bf16_f32 v73, v74, v75
    ds_write_b64 v36, v[72:73] offset:9216
    v_cvt_pk_bf16_f32 v76, v76, v77
    v_cvt_pk_bf16_f32 v77, v78, v79
    ds_write_b64 v36, v[76:77] offset:9472
    ds_read_b128 v[144:147], v45 offset:8192
    ds_read_b128 v[148:151], v45 offset:9216
    s_waitcnt vmcnt(6)
    v_mfma_f32_32x32x16_bf16 v[48:63], a[16:19], v[136:139], 0
    v_exp_f32 v80, v80
    v_exp_f32 v81, v81
    v_exp_f32 v82, v82
    v_mfma_f32_32x32x16_bf16 v[48:63], a[20:23], v[140:143], v[48:63]
    v_exp_f32 v83, v83
    v_exp_f32 v84, v84
    v_exp_f32 v85, v85
    s_add_u32 s12, s12, 4096
    s_addc_u32 s13, s13, 0
    v_exp_f32 v86, v86
    v_exp_f32 v87, v87
    v_exp_f32 v88, v88
    buffer_load_dwordx4 a[48:51], v37, s[12:15], 0 offen offset:0 sc1
    v_exp_f32 v89, v89
    v_exp_f32 v90, v90
    v_smfmac_f32_32x32x32_bf16 v[96:111], a[8:11], v[80:87], v44
    s_waitcnt lgkmcnt(0)
    v_exp_f32 v91, v91
    v_exp_f32 v92, v92
    v_exp_f32 v93, v93
    v_smfmac_f32_16x16x64_bf16 v[128:131], v[40:43], v[80:87], v44
    buffer_load_dwordx4 a[52:55], v37, s[12:15], 0 offen offset:1024 sc1
    v_exp_f32 v94, v94
    v_exp_f32 v95, v95
    v_mfma_f32_32x32x16_bf16 v[64:79], a[0:3], v[144:147], 0
    s_waitcnt vmcnt(4)
    v_exp_f32 v48, v48
    v_exp_f32 v49, v49
    v_exp_f32 v50, v50
    v_mfma_f32_32x32x16_bf16 v[64:79], a[4:7], v[148:151], v[64:79]
    v_exp_f32 v51, v51
    v_exp_f32 v52, v52
    v_exp_f32 v53, v53
    v_smfmac_f32_32x32x32_bf16 v[96:111], a[12:15], v[88:95], v44
    buffer_load_dwordx4 a[56:59], v37, s[12:15], 0 offen offset:2048 sc1
    v_exp_f32 v54, v54
    v_exp_f32 v55, v55
    v_exp_f32 v56, v56
    v_smfmac_f32_16x16x64_bf16 v[128:131], v[40:43], v[88:95], v44
    buffer_load_dwordx4 a[60:63], v37, s[12:15], 0 offen offset:3072 sc1
    v_exp_f32 v57, v57
    v_exp_f32 v58, v58
    v_smfmac_f32_32x32x32_bf16 v[96:111], a[24:27], v[48:55], v44
    s_add_u32 s12, s12, 4096
    s_addc_u32 s13, s13, 0
    v_exp_f32 v59, v59
    v_exp_f32 v60, v60
    v_exp_f32 v61, v61
    v_smfmac_f32_16x16x64_bf16 v[128:131], v[40:43], v[48:55], v44
    buffer_load_dwordx4 a[64:67], v37, s[12:15], 0 offen offset:0 sc1
    v_exp_f32 v62, v62
    v_exp_f32 v63, v63
    v_mfma_f32_32x32x16_bf16 v[80:95], a[32:35], v[136:139], 0
    s_barrier
    v_exp_f32 v64, v64
    v_exp_f32 v65, v65
    v_exp_f32 v66, v66
    v_mfma_f32_32x32x16_bf16 v[80:95], a[36:39], v[140:143], v[80:95]
    v_exp_f32 v67, v67
    v_exp_f32 v68, v68
    v_exp_f32 v69, v69
    v_smfmac_f32_32x32x32_bf16 v[96:111], a[28:31], v[56:63], v44
    v_exp_f32 v70, v70
    v_exp_f32 v71, v71
    v_exp_f32 v72, v72
    v_smfmac_f32_16x16x64_bf16 v[128:131], v[40:43], v[56:63], v44
    buffer_load_dwordx4 a[68:71], v37, s[12:15], 0 offen offset:1024 sc1
    v_exp_f32 v73, v73
    v_exp_f32 v74, v74
    v_smfmac_f32_32x32x32_bf16 v[112:127], a[8:11], v[64:71], v44
    v_exp_f32 v75, v75
    v_exp_f32 v76, v76
    v_exp_f32 v77, v77
    v_smfmac_f32_16x16x64_bf16 v[132:135], v[40:43], v[64:71], v44
    buffer_load_dwordx4 a[72:75], v37, s[12:15], 0 offen offset:2048 sc1
    v_exp_f32 v78, v78
    v_exp_f32 v79, v79
    v_mfma_f32_32x32x16_bf16 v[48:63], a[16:19], v[144:147], 0
    ds_read_b128 v[152:155], v28 offset:0
    v_exp_f32 v80, v80
    v_exp_f32 v81, v81
    v_exp_f32 v82, v82
    v_mfma_f32_32x32x16_bf16 v[48:63], a[20:23], v[148:151], v[48:63]
    s_waitcnt vmcnt(7)
    ds_read_b128 v[156:159], v28 offset:1024
    v_exp_f32 v83, v83
    v_exp_f32 v84, v84
    v_exp_f32 v85, v85
    v_smfmac_f32_32x32x32_bf16 v[112:127], a[12:15], v[72:79], v44
    s_waitcnt vmcnt(5)
    v_exp_f32 v86, v86
    v_exp_f32 v87, v87
    v_exp_f32 v88, v88
    v_smfmac_f32_16x16x64_bf16 v[132:135], v[40:43], v[72:79], v44
    buffer_load_dwordx4 a[76:79], v37, s[12:15], 0 offen offset:3072 sc1
    v_exp_f32 v89, v89
    v_exp_f32 v90, v90
    v_smfmac_f32_32x32x32_bf16 v[96:111], a[40:43], v[80:87], v44
    s_add_u32 s12, s12, 4096
    s_addc_u32 s13, s13, 0
    v_exp_f32 v91, v91
    v_exp_f32 v92, v92
    v_exp_f32 v93, v93
    v_smfmac_f32_16x16x64_bf16 v[128:131], v[40:43], v[80:87], v44
    buffer_load_dwordx4 a[80:83], v37, s[12:15], 0 offen offset:0 sc1
    v_exp_f32 v94, v94
    v_exp_f32 v95, v95
    v_mfma_f32_32x32x16_bf16 v[64:79], a[48:51], v[136:139], 0
    v_exp_f32 v48, v48
    v_exp_f32 v49, v49
    v_exp_f32 v50, v50
    v_mfma_f32_32x32x16_bf16 v[64:79], a[52:55], v[140:143], v[64:79]
    v_exp_f32 v51, v51
    v_exp_f32 v52, v52
    v_exp_f32 v53, v53
    v_smfmac_f32_32x32x32_bf16 v[96:111], a[44:47], v[88:95], v44
    buffer_load_dwordx4 a[84:87], v37, s[12:15], 0 offen offset:1024 sc1
    v_exp_f32 v54, v54
    v_exp_f32 v55, v55
    v_exp_f32 v56, v56
    v_smfmac_f32_16x16x64_bf16 v[128:131], v[40:43], v[88:95], v44
    buffer_load_dwordx4 a[88:91], v37, s[12:15], 0 offen offset:2048 sc1
    v_exp_f32 v57, v57
    v_exp_f32 v58, v58
    v_smfmac_f32_32x32x32_bf16 v[112:127], a[24:27], v[48:55], v44
    v_exp_f32 v59, v59
    v_exp_f32 v60, v60
    v_exp_f32 v61, v61
    v_smfmac_f32_16x16x64_bf16 v[132:135], v[40:43], v[48:55], v44
    buffer_load_dwordx4 a[92:95], v37, s[12:15], 0 offen offset:3072 sc1
    v_exp_f32 v62, v62
    v_exp_f32 v63, v63
    v_mfma_f32_32x32x16_bf16 v[80:95], a[32:35], v[144:147], 0
    ds_read_b128 v[160:163], v28 offset:8192
    v_exp_f32 v64, v64
    v_exp_f32 v65, v65
    v_exp_f32 v66, v66
    v_mfma_f32_32x32x16_bf16 v[80:95], a[36:39], v[148:151], v[80:95]
    s_waitcnt vmcnt(8)
    ds_read_b128 v[164:167], v28 offset:9216
    v_exp_f32 v67, v67
    v_exp_f32 v68, v68
    v_exp_f32 v69, v69
    v_smfmac_f32_32x32x32_bf16 v[112:127], a[28:31], v[56:63], v44
    s_add_u32 s12, s12, 4096
    s_addc_u32 s13, s13, 0
    v_exp_f32 v70, v70
    v_exp_f32 v71, v71
    v_exp_f32 v72, v72
    v_smfmac_f32_16x16x64_bf16 v[132:135], v[40:43], v[56:63], v44
    buffer_load_dwordx4 a[96:99], v37, s[12:15], 0 offen offset:0 sc1
    v_exp_f32 v73, v73
    v_exp_f32 v74, v74
    v_smfmac_f32_32x32x32_bf16 v[96:111], a[56:59], v[64:71], v44
    s_waitcnt vmcnt(7)
    v_exp_f32 v75, v75
    v_exp_f32 v76, v76
    v_exp_f32 v77, v77
    v_smfmac_f32_16x16x64_bf16 v[128:131], v[40:43], v[64:71], v44
    buffer_load_dwordx4 a[100:103], v37, s[12:15], 0 offen offset:1024 sc1
    v_exp_f32 v78, v78
    v_exp_f32 v79, v79
    v_mfma_f32_32x32x16_bf16 v[48:63], a[64:67], v[136:139], 0
    v_exp_f32 v80, v80
    v_exp_f32 v81, v81
    v_exp_f32 v82, v82
    v_mfma_f32_32x32x16_bf16 v[48:63], a[68:71], v[140:143], v[48:63]
    v_exp_f32 v83, v83
    v_exp_f32 v84, v84
    v_exp_f32 v85, v85
    v_smfmac_f32_32x32x32_bf16 v[96:111], a[60:63], v[72:79], v44
    buffer_load_dwordx4 a[104:107], v37, s[12:15], 0 offen offset:2048 sc1
    v_exp_f32 v86, v86
    v_exp_f32 v87, v87
    v_exp_f32 v88, v88
    v_smfmac_f32_16x16x64_bf16 v[128:131], v[40:43], v[72:79], v44
    buffer_load_dwordx4 a[108:111], v37, s[12:15], 0 offen offset:3072 sc1
    v_exp_f32 v89, v89
    v_exp_f32 v90, v90
    v_smfmac_f32_32x32x32_bf16 v[112:127], a[40:43], v[80:87], v44
    s_add_u32 s12, s12, 4096
    s_addc_u32 s13, s13, 0
    v_exp_f32 v91, v91
    v_exp_f32 v92, v92
    v_exp_f32 v93, v93
    v_smfmac_f32_16x16x64_bf16 v[132:135], v[40:43], v[80:87], v44
    buffer_load_dwordx4 a[112:115], v37, s[12:15], 0 offen offset:0 sc1
    v_exp_f32 v94, v94
    v_exp_f32 v95, v95
    v_mfma_f32_32x32x16_bf16 v[64:79], a[48:51], v[144:147], 0
    ds_read_b128 v[168:171], v29 offset:0
    v_exp_f32 v48, v48
    v_exp_f32 v49, v49
    v_exp_f32 v50, v50
    v_mfma_f32_32x32x16_bf16 v[64:79], a[52:55], v[148:151], v[64:79]
    s_waitcnt vmcnt(9)
    ds_read_b128 v[172:175], v29 offset:1024
    v_exp_f32 v51, v51
    v_exp_f32 v52, v52
    v_exp_f32 v53, v53
    v_smfmac_f32_32x32x32_bf16 v[112:127], a[44:47], v[88:95], v44
    v_exp_f32 v54, v54
    v_exp_f32 v55, v55
    v_exp_f32 v56, v56
    v_smfmac_f32_16x16x64_bf16 v[132:135], v[40:43], v[88:95], v44
    buffer_load_dwordx4 a[116:119], v37, s[12:15], 0 offen offset:1024 sc1
    v_exp_f32 v57, v57
    v_exp_f32 v58, v58
    v_smfmac_f32_32x32x32_bf16 v[96:111], a[72:75], v[48:55], v44
    s_waitcnt vmcnt(8)
    v_exp_f32 v59, v59
    v_exp_f32 v60, v60
    v_exp_f32 v61, v61
    v_smfmac_f32_16x16x64_bf16 v[128:131], v[40:43], v[48:55], v44
    buffer_load_dwordx4 a[120:123], v37, s[12:15], 0 offen offset:2048 sc1
    v_exp_f32 v62, v62
    v_exp_f32 v63, v63
    v_mfma_f32_32x32x16_bf16 v[80:95], a[80:83], v[136:139], 0
    v_exp_f32 v64, v64
    v_exp_f32 v65, v65
    v_exp_f32 v66, v66
    v_mfma_f32_32x32x16_bf16 v[80:95], a[84:87], v[140:143], v[80:95]
    v_exp_f32 v67, v67
    v_exp_f32 v68, v68
    v_exp_f32 v69, v69
    v_smfmac_f32_32x32x32_bf16 v[96:111], a[76:79], v[56:63], v44
    v_exp_f32 v70, v70
    v_exp_f32 v71, v71
    v_exp_f32 v72, v72
    v_smfmac_f32_16x16x64_bf16 v[128:131], v[40:43], v[56:63], v44
    buffer_load_dwordx4 a[124:127], v37, s[12:15], 0 offen offset:3072 sc1
    v_exp_f32 v73, v73
    v_exp_f32 v74, v74
    v_smfmac_f32_32x32x32_bf16 v[112:127], a[56:59], v[64:71], v44
    s_add_u32 s12, s12, 4096
    s_addc_u32 s13, s13, 0
    v_exp_f32 v75, v75
    v_exp_f32 v76, v76
    v_exp_f32 v77, v77
    v_smfmac_f32_16x16x64_bf16 v[132:135], v[40:43], v[64:71], v44
    buffer_load_dwordx4 a[128:131], v37, s[12:15], 0 offen offset:0 sc1
    v_exp_f32 v78, v78
    v_exp_f32 v79, v79
    v_mfma_f32_32x32x16_bf16 v[48:63], a[64:67], v[144:147], 0
    ds_read_b128 v[176:179], v29 offset:8192
    v_exp_f32 v80, v80
    v_exp_f32 v81, v81
    v_exp_f32 v82, v82
    v_mfma_f32_32x32x16_bf16 v[48:63], a[68:71], v[148:151], v[48:63]
    s_waitcnt vmcnt(9)
    ds_read_b128 v[180:183], v29 offset:9216
    v_exp_f32 v83, v83
    v_exp_f32 v84, v84
    v_exp_f32 v85, v85
    v_smfmac_f32_32x32x32_bf16 v[112:127], a[60:63], v[72:79], v44
    buffer_load_dwordx4 a[132:135], v37, s[12:15], 0 offen offset:1024 sc1
    v_exp_f32 v86, v86
    v_exp_f32 v87, v87
    v_exp_f32 v88, v88
    v_smfmac_f32_16x16x64_bf16 v[132:135], v[40:43], v[72:79], v44
    buffer_load_dwordx4 a[136:139], v37, s[12:15], 0 offen offset:2048 sc1
    v_exp_f32 v89, v89
    v_exp_f32 v90, v90
    v_smfmac_f32_32x32x32_bf16 v[96:111], a[88:91], v[80:87], v44
    s_waitcnt vmcnt(9)
    v_exp_f32 v91, v91
    v_exp_f32 v92, v92
    v_exp_f32 v93, v93
    v_smfmac_f32_16x16x64_bf16 v[128:131], v[40:43], v[80:87], v44
    buffer_load_dwordx4 a[140:143], v37, s[12:15], 0 offen offset:3072 sc1
    v_exp_f32 v94, v94
    v_exp_f32 v95, v95
    v_mfma_f32_32x32x16_bf16 v[64:79], a[96:99], v[136:139], 0
    v_exp_f32 v48, v48
    v_exp_f32 v49, v49
    v_exp_f32 v50, v50
    v_mfma_f32_32x32x16_bf16 v[64:79], a[100:103], v[140:143], v[64:79]
    v_exp_f32 v51, v51
    v_exp_f32 v52, v52
    v_exp_f32 v53, v53
    v_smfmac_f32_32x32x32_bf16 v[96:111], a[92:95], v[88:95], v44
    s_add_u32 s12, s12, 4096
    s_addc_u32 s13, s13, 0
    v_exp_f32 v54, v54
    v_exp_f32 v55, v55
    v_exp_f32 v56, v56
    v_smfmac_f32_16x16x64_bf16 v[128:131], v[40:43], v[88:95], v44
    buffer_load_dwordx4 a[144:147], v37, s[12:15], 0 offen offset:0 sc1
    v_exp_f32 v57, v57
    v_exp_f32 v58, v58
    v_smfmac_f32_32x32x32_bf16 v[112:127], a[72:75], v[48:55], v44
    v_exp_f32 v59, v59
    v_exp_f32 v60, v60
    v_exp_f32 v61, v61
    v_smfmac_f32_16x16x64_bf16 v[132:135], v[40:43], v[48:55], v44
    buffer_load_dwordx4 a[148:151], v37, s[12:15], 0 offen offset:1024 sc1
    v_exp_f32 v62, v62
L_pad2:
    s_cbranch_execz L_pad3
    v_exp_f32 v63, v63
    v_mfma_f32_32x32x16_bf16 v[80:95], a[80:83], v[144:147], 0
    s_waitcnt vmcnt(8)
    ds_read_b128 v[184:187], v30 offset:0
    v_exp_f32 v64, v64
    v_exp_f32 v65, v65
    v_exp_f32 v66, v66
    v_mfma_f32_32x32x16_bf16 v[80:95], a[84:87], v[148:151], v[80:95]
    ds_read_b128 v[188:191], v30 offset:1024
    v_exp_f32 v67, v67
    v_exp_f32 v68, v68
    v_exp_f32 v69, v69
    v_smfmac_f32_32x32x32_bf16 v[112:127], a[76:79], v[56:63], v44
    buffer_load_dwordx4 a[152:155], v37, s[12:15], 0 offen offset:2048 sc1
    v_exp_f32 v70, v70
    v_exp_f32 v71, v71
    v_exp_f32 v72, v72
    v_smfmac_f32_16x16x64_bf16 v[132:135], v[40:43], v[56:63], v44
    buffer_load_dwordx4 a[156:159], v37, s[12:15], 0 offen offset:3072 sc1
    v_exp_f32 v73, v73
    v_exp_f32 v74, v74
    v_smfmac_f32_32x32x32_bf16 v[96:111], a[104:107], v[64:71], v44
    s_add_u32 s12, s12, 4096
    s_addc_u32 s13, s13, 0
    v_exp_f32 v75, v75
    v_exp_f32 v76, v76
    v_exp_f32 v77, v77
    v_smfmac_f32_16x16x64_bf16 v[128:131], v[40:43], v[64:71], v44
    buffer_load_dwordx4 a[160:163], v37, s[12:15], 0 offen offset:0 sc1
    v_exp_f32 v78, v78
    v_exp_f32 v79, v79
    v_mfma_f32_32x32x16_bf16 v[48:63], a[112:115], v[136:139], 0
    v_exp_f32 v80, v80
    v_exp_f32 v81, v81
    v_exp_f32 v82, v82
    v_mfma_f32_32x32x16_bf16 v[48:63], a[116:119], v[140:143], v[48:63]
    v_exp_f32 v83, v83
    v_exp_f32 v84, v84
    v_exp_f32 v85, v85
    v_smfmac_f32_32x32x32_bf16 v[96:111], a[108:111], v[72:79], v44
    v_exp_f32 v86, v86
    v_exp_f32 v87, v87
    v_exp_f32 v88, v88
    v_smfmac_f32_16x16x64_bf16 v[128:131], v[40:43], v[72:79], v44
    buffer_load_dwordx4 a[164:167], v37, s[12:15], 0 offen offset:1024 sc1
    v_exp_f32 v89, v89
    v_exp_f32 v90, v90
    v_smfmac_f32_32x32x32_bf16 v[112:127], a[88:91], v[80:87], v44
    v_exp_f32 v91, v91
    v_exp_f32 v92, v92
    v_exp_f32 v93, v93
    v_smfmac_f32_16x16x64_bf16 v[132:135], v[40:43], v[80:87], v44
    buffer_load_dwordx4 a[168:171], v37, s[12:15], 0 offen offset:2048 sc1
    v_exp_f32 v94, v94
    v_exp_f32 v95, v95
    v_mfma_f32_32x32x16_bf16 v[64:79], a[96:99], v[144:147], 0
    ds_read_b128 v[192:195], v30 offset:8192
    v_exp_f32 v48, v48
    v_exp_f32 v49, v49
    v_exp_f32 v50, v50
    v_mfma_f32_32x32x16_bf16 v[64:79], a[100:103], v[148:151], v[64:79]
    s_waitcnt vmcnt(11)
    ds_read_b128 v[196:199], v30 offset:9216
    v_exp_f32 v51, v51
    v_exp_f32 v52, v52
    v_exp_f32 v53, v53
    v_smfmac_f32_32x32x32_bf16 v[112:127], a[92:95], v[88:95], v44
    s_waitcnt vmcnt(9)
    v_exp_f32 v54, v54
    v_exp_f32 v55, v55
    v_exp_f32 v56, v56
    v_smfmac_f32_16x16x64_bf16 v[132:135], v[40:43], v[88:95], v44
    buffer_load_dwordx4 a[172:175], v37, s[12:15], 0 offen offset:3072 sc1
    v_exp_f32 v57, v57
    v_exp_f32 v58, v58
    v_smfmac_f32_32x32x32_bf16 v[96:111], a[120:123], v[48:55], v44
    s_add_u32 s12, s12, 4096
    s_addc_u32 s13, s13, 0
    v_exp_f32 v59, v59
    v_exp_f32 v60, v60
    v_exp_f32 v61, v61
    v_smfmac_f32_16x16x64_bf16 v[128:131], v[40:43], v[48:55], v44
    buffer_load_dwordx4 a[176:179], v37, s[12:15], 0 offen offset:0 sc1
    v_exp_f32 v62, v62
    v_exp_f32 v63, v63
    v_mfma_f32_32x32x16_bf16 v[80:95], a[128:131], v[136:139], 0
    v_exp_f32 v64, v64
    v_exp_f32 v65, v65
    v_exp_f32 v66, v66
    v_mfma_f32_32x32x16_bf16 v[80:95], a[132:135], v[140:143], v[80:95]
    v_exp_f32 v67, v67
    v_exp_f32 v68, v68
    v_exp_f32 v69, v69
    v_smfmac_f32_32x32x32_bf16 v[96:111], a[124:127], v[56:63], v44
    buffer_load_dwordx4 a[180:183], v37, s[12:15], 0 offen offset:1024 sc1
    v_exp_f32 v70, v70
    v_exp_f32 v71, v71
    v_exp_f32 v72, v72
    v_smfmac_f32_16x16x64_bf16 v[128:131], v[40:43], v[56:63], v44
    buffer_load_dwordx4 a[184:187], v37, s[12:15], 0 offen offset:2048 sc1
    v_exp_f32 v73, v73
    v_exp_f32 v74, v74
    v_smfmac_f32_32x32x32_bf16 v[112:127], a[104:107], v[64:71], v44
    v_exp_f32 v75, v75
    v_exp_f32 v76, v76
    v_exp_f32 v77, v77
    v_smfmac_f32_16x16x64_bf16 v[132:135], v[40:43], v[64:71], v44
    buffer_load_dwordx4 a[188:191], v37, s[12:15], 0 offen offset:3072 sc1
    v_exp_f32 v78, v78
    v_exp_f32 v79, v79
    v_mfma_f32_32x32x16_bf16 v[48:63], a[112:115], v[144:147], 0
    v_exp_f32 v80, v80
    v_exp_f32 v81, v81
    v_exp_f32 v82, v82
    v_mfma_f32_32x32x16_bf16 v[48:63], a[116:119], v[148:151], v[48:63]
    s_waitcnt vmcnt(12)
    v_exp_f32 v83, v83
    v_exp_f32 v84, v84
    v_exp_f32 v85, v85
    v_smfmac_f32_32x32x32_bf16 v[112:127], a[108:111], v[72:79], v44
    s_add_u32 s12, s12, 4096
    s_addc_u32 s13, s13, 0
    v_exp_f32 v86, v86
    v_exp_f32 v87, v87
    v_exp_f32 v88, v88
    v_smfmac_f32_16x16x64_bf16 v[132:135], v[40:43], v[72:79], v44
    buffer_load_dwordx4 a[192:195], v37, s[12:15], 0 offen offset:0 sc1
    v_exp_f32 v89, v89
    v_exp_f32 v90, v90
    v_smfmac_f32_32x32x32_bf16 v[96:111], a[136:139], v[80:87], v44
    s_waitcnt vmcnt(11)
    v_exp_f32 v91, v91
    v_exp_f32 v92, v92
    v_exp_f32 v93, v93
    v_smfmac_f32_16x16x64_bf16 v[128:131], v[40:43], v[80:87], v44
    buffer_load_dwordx4 a[196:199], v37, s[12:15], 0 offen offset:1024 sc1
    v_exp_f32 v94, v94
    v_exp_f32 v95, v95
    v_mfma_f32_32x32x16_bf16 v[64:79], a[144:147], v[136:139], 0
    v_exp_f32 v48, v48
    v_exp_f32 v49, v49
    v_exp_f32 v50, v50
    v_mfma_f32_32x32x16_bf16 v[64:79], a[148:151], v[140:143], v[64:79]
    v_exp_f32 v51, v51
    v_exp_f32 v52, v52
    v_exp_f32 v53, v53
    v_smfmac_f32_32x32x32_bf16 v[96:111], a[140:143], v[88:95], v44
    buffer_load_dwordx4 a[200:203], v37, s[12:15], 0 offen offset:2048 sc1
    v_exp_f32 v54, v54
    v_exp_f32 v55, v55
    v_exp_f32 v56, v56
    v_smfmac_f32_16x16x64_bf16 v[128:131], v[40:43], v[88:95], v44
    buffer_load_dwordx4 a[204:207], v37, s[12:15], 0 offen offset:3072 sc1
    v_exp_f32 v57, v57
    v_exp_f32 v58, v58
    v_smfmac_f32_32x32x32_bf16 v[112:127], a[120:123], v[48:55], v44
    s_add_u32 s12, s12, 4096
    s_addc_u32 s13, s13, 0
    v_exp_f32 v59, v59
    v_exp_f32 v60, v60
    v_exp_f32 v61, v61
    v_smfmac_f32_16x16x64_bf16 v[132:135], v[40:43], v[48:55], v44
    buffer_load_dwordx4 a[208:211], v37, s[12:15], 0 offen offset:0 sc1
    v_exp_f32 v62, v62
    v_exp_f32 v63, v63
    v_mfma_f32_32x32x16_bf16 v[80:95], a[128:131], v[144:147], 0
    v_exp_f32 v64, v64
    v_exp_f32 v65, v65
    v_exp_f32 v66, v66
    v_mfma_f32_32x32x16_bf16 v[80:95], a[132:135], v[148:151], v[80:95]
    s_waitcnt vmcnt(13)
    v_exp_f32 v67, v67
    v_exp_f32 v68, v68
    v_exp_f32 v69, v69
    v_smfmac_f32_32x32x32_bf16 v[112:127], a[124:127], v[56:63], v44
    v_exp_f32 v70, v70
    v_exp_f32 v71, v71
    v_exp_f32 v72, v72
    v_smfmac_f32_16x16x64_bf16 v[132:135], v[40:43], v[56:63], v44
    buffer_load_dwordx4 a[212:215], v37, s[12:15], 0 offen offset:1024 sc1
    v_exp_f32 v73, v73
    v_exp_f32 v74, v74
    v_smfmac_f32_32x32x32_bf16 v[96:111], a[152:155], v[64:71], v44
    s_waitcnt vmcnt(12)
    v_exp_f32 v75, v75
    v_exp_f32 v76, v76
    v_exp_f32 v77, v77
    v_smfmac_f32_16x16x64_bf16 v[128:131], v[40:43], v[64:71], v44
    buffer_load_dwordx4 a[216:219], v37, s[12:15], 0 offen offset:2048 sc1
    v_exp_f32 v78, v78
    v_exp_f32 v79, v79
    v_mfma_f32_32x32x16_bf16 v[48:63], a[160:163], v[136:139], 0
    v_exp_f32 v80, v80
    v_exp_f32 v81, v81
    v_exp_f32 v82, v82
    v_mfma_f32_32x32x16_bf16 v[48:63], a[164:167], v[140:143], v[48:63]
    v_exp_f32 v83, v83
    v_exp_f32 v84, v84
    v_exp_f32 v85, v85
    v_smfmac_f32_32x32x32_bf16 v[96:111], a[156:159], v[72:79], v44
    v_exp_f32 v86, v86
    v_exp_f32 v87, v87
    v_exp_f32 v88, v88
    v_smfmac_f32_16x16x64_bf16 v[128:131], v[40:43], v[72:79], v44
    buffer_load_dwordx4 a[220:223], v37, s[12:15], 0 offen offset:3072 sc1
    v_exp_f32 v89, v89
    v_exp_f32 v90, v90
    v_smfmac_f32_32x32x32_bf16 v[112:127], a[136:139], v[80:87], v44
    s_add_u32 s12, s12, 4096
    s_addc_u32 s13, s13, 0
    v_exp_f32 v91, v91
    v_exp_f32 v92, v92
    v_exp_f32 v93, v93
    v_smfmac_f32_16x16x64_bf16 v[132:135], v[40:43], v[80:87], v44
    buffer_load_dwordx4 a[224:227], v37, s[12:15], 0 offen offset:0 sc1
    v_exp_f32 v94, v94
    v_exp_f32 v95, v95
    v_mfma_f32_32x32x16_bf16 v[64:79], a[144:147], v[144:147], 0
    v_exp_f32 v48, v48
    v_exp_f32 v49, v49
    v_exp_f32 v50, v50
    v_mfma_f32_32x32x16_bf16 v[64:79], a[148:151], v[148:151], v[64:79]
    s_waitcnt vmcnt(13)
    v_exp_f32 v51, v51
    v_exp_f32 v52, v52
    v_exp_f32 v53, v53
    v_smfmac_f32_32x32x32_bf16 v[112:127], a[140:143], v[88:95], v44
    v_exp_f32 v54, v54
    v_exp_f32 v55, v55
    v_exp_f32 v56, v56
    v_smfmac_f32_16x16x64_bf16 v[132:135], v[40:43], v[88:95], v44
    buffer_load_dwordx4 a[228:231], v37, s[12:15], 0 offen offset:1024 sc1
    v_exp_f32 v57, v57
    v_exp_f32 v58, v58
    v_smfmac_f32_32x32x32_bf16 v[96:111], a[168:171], v[48:55], v44
    s_waitcnt vmcnt(12)
    v_exp_f32 v59, v59
    v_exp_f32 v60, v60
    v_exp_f32 v61, v61
    v_smfmac_f32_16x16x64_bf16 v[128:131], v[40:43], v[48:55], v44
    buffer_load_dwordx4 a[232:235], v37, s[12:15], 0 offen offset:2048 sc1
    v_exp_f32 v62, v62
    v_exp_f32 v63, v63
    v_mfma_f32_32x32x16_bf16 v[80:95], a[176:179], v[136:139], 0
    v_exp_f32 v64, v64
    v_exp_f32 v65, v65
    v_exp_f32 v66, v66
    v_mfma_f32_32x32x16_bf16 v[80:95], a[180:183], v[140:143], v[80:95]
    v_exp_f32 v67, v67
    v_exp_f32 v68, v68
    v_exp_f32 v69, v69
    v_smfmac_f32_32x32x32_bf16 v[96:111], a[172:175], v[56:63], v44
    v_exp_f32 v70, v70
    v_exp_f32 v71, v71
    v_exp_f32 v72, v72
    v_smfmac_f32_16x16x64_bf16 v[128:131], v[40:43], v[56:63], v44
    buffer_load_dwordx4 a[236:239], v37, s[12:15], 0 offen offset:3072 sc1
    v_exp_f32 v73, v73
    v_exp_f32 v74, v74
    v_smfmac_f32_32x32x32_bf16 v[112:127], a[152:155], v[64:71], v44
    s_add_u32 s12, s12, 4096
    s_addc_u32 s13, s13, 0
    v_exp_f32 v75, v75
    v_exp_f32 v76, v76
    v_exp_f32 v77, v77
    v_smfmac_f32_16x16x64_bf16 v[132:135], v[40:43], v[64:71], v44
    buffer_load_dwordx4 a[240:243], v37, s[12:15], 0 offen offset:0 sc1
    v_exp_f32 v78, v78
    v_exp_f32 v79, v79
    v_mfma_f32_32x32x16_bf16 v[48:63], a[160:163], v[144:147], 0
    v_exp_f32 v80, v80
    v_exp_f32 v81, v81
    v_exp_f32 v82, v82
    v_mfma_f32_32x32x16_bf16 v[48:63], a[164:167], v[148:151], v[48:63]
    s_waitcnt vmcnt(13)
    v_exp_f32 v83, v83
    v_exp_f32 v84, v84
    v_exp_f32 v85, v85
    v_smfmac_f32_32x32x32_bf16 v[112:127], a[156:159], v[72:79], v44
    v_exp_f32 v86, v86
    v_exp_f32 v87, v87
    v_exp_f32 v88, v88
    v_smfmac_f32_16x16x64_bf16 v[132:135], v[40:43], v[72:79], v44
    buffer_load_dwordx4 a[244:247], v37, s[12:15], 0 offen offset:1024 sc1
    v_exp_f32 v89, v89
    v_exp_f32 v90, v90
    v_smfmac_f32_32x32x32_bf16 v[96:111], a[184:187], v[80:87], v44
    s_waitcnt vmcnt(12)
    v_exp_f32 v91, v91
    v_exp_f32 v92, v92
    v_exp_f32 v93, v93
    v_smfmac_f32_16x16x64_bf16 v[128:131], v[40:43], v[80:87], v44
    buffer_load_dwordx4 a[248:251], v37, s[12:15], 0 offen offset:2048 sc1
    v_exp_f32 v94, v94
    v_exp_f32 v95, v95
    v_mfma_f32_32x32x16_bf16 v[64:79], a[192:195], v[136:139], 0
    v_exp_f32 v48, v48
    v_exp_f32 v49, v49
    v_exp_f32 v50, v50
    v_mfma_f32_32x32x16_bf16 v[64:79], a[196:199], v[140:143], v[64:79]
    v_exp_f32 v51, v51
    v_exp_f32 v52, v52
    v_exp_f32 v53, v53
    v_smfmac_f32_32x32x32_bf16 v[96:111], a[188:191], v[88:95], v44
    v_exp_f32 v54, v54
    v_exp_f32 v55, v55
    v_exp_f32 v56, v56
    v_smfmac_f32_16x16x64_bf16 v[128:131], v[40:43], v[88:95], v44
    buffer_load_dwordx4 a[252:255], v37, s[12:15], 0 offen offset:3072 sc1
    v_exp_f32 v57, v57
    v_exp_f32 v58, v58
    v_smfmac_f32_32x32x32_bf16 v[112:127], a[168:171], v[48:55], v44
    s_waitcnt vmcnt(10)
    v_exp_f32 v59, v59
    v_exp_f32 v60, v60
    v_exp_f32 v61, v61
    v_smfmac_f32_16x16x64_bf16 v[132:135], v[40:43], v[48:55], v44
    v_exp_f32 v62, v62
    v_exp_f32 v63, v63
    v_mfma_f32_32x32x16_bf16 v[80:95], a[208:211], v[136:139], 0
    v_exp_f32 v64, v64
    v_exp_f32 v65, v65
    v_exp_f32 v66, v66
    v_mfma_f32_32x32x16_bf16 v[80:95], a[212:215], v[140:143], v[80:95]
    v_exp_f32 v67, v67
    v_exp_f32 v68, v68
    v_exp_f32 v69, v69
    v_smfmac_f32_32x32x32_bf16 v[112:127], a[172:175], v[56:63], v44
    v_exp_f32 v70, v70
    v_exp_f32 v71, v71
    v_exp_f32 v72, v72
    v_smfmac_f32_16x16x64_bf16 v[132:135], v[40:43], v[56:63], v44
    v_exp_f32 v73, v73
    v_exp_f32 v74, v74
    v_smfmac_f32_32x32x32_bf16 v[96:111], a[200:203], v[64:71], v44
    v_exp_f32 v75, v75
    v_exp_f32 v76, v76
    v_exp_f32 v77, v77
    v_smfmac_f32_16x16x64_bf16 v[128:131], v[40:43], v[64:71], v44
    v_exp_f32 v78, v78
    v_exp_f32 v79, v79
    v_mfma_f32_32x32x16_bf16 v[48:63], a[176:179], v[144:147], 0
    v_exp_f32 v80, v80
    v_exp_f32 v81, v81
    v_exp_f32 v82, v82
    v_mfma_f32_32x32x16_bf16 v[48:63], a[180:183], v[148:151], v[48:63]
    s_waitcnt vmcnt(8)
    v_exp_f32 v83, v83
    v_exp_f32 v84, v84
    v_exp_f32 v85, v85
    v_smfmac_f32_32x32x32_bf16 v[96:111], a[204:207], v[72:79], v44
    v_exp_f32 v86, v86
    v_exp_f32 v87, v87
    v_exp_f32 v88, v88
    v_smfmac_f32_16x16x64_bf16 v[128:131], v[40:43], v[72:79], v44
    v_exp_f32 v89, v89
    v_exp_f32 v90, v90
    v_smfmac_f32_32x32x32_bf16 v[96:111], a[216:219], v[80:87], v44
    s_waitcnt vmcnt(6)
    v_exp_f32 v91, v91
    v_exp_f32 v92, v92
    v_exp_f32 v93, v93
    v_smfmac_f32_16x16x64_bf16 v[128:131], v[40:43], v[80:87], v44
    v_exp_f32 v94, v94
    v_exp_f32 v95, v95
    v_mfma_f32_32x32x16_bf16 v[64:79], a[224:227], v[136:139], 0
    v_exp_f32 v48, v48
    v_exp_f32 v49, v49
    v_exp_f32 v50, v50
    v_mfma_f32_32x32x16_bf16 v[64:79], a[228:231], v[140:143], v[64:79]
    v_exp_f32 v51, v51
    v_exp_f32 v52, v52
    v_exp_f32 v53, v53
    v_smfmac_f32_32x32x32_bf16 v[96:111], a[220:223], v[88:95], v44
    v_exp_f32 v54, v54
    v_exp_f32 v55, v55
    v_exp_f32 v56, v56
    v_smfmac_f32_16x16x64_bf16 v[128:131], v[40:43], v[88:95], v44
    v_exp_f32 v57, v57
    v_exp_f32 v58, v58
    v_smfmac_f32_32x32x32_bf16 v[112:127], a[184:187], v[48:55], v44
    s_waitcnt vmcnt(2)
    v_exp_f32 v59, v59
    v_exp_f32 v60, v60
    v_exp_f32 v61, v61
    v_smfmac_f32_16x16x64_bf16 v[132:135], v[40:43], v[48:55], v44
    v_exp_f32 v62, v62
    v_exp_f32 v63, v63
    v_mfma_f32_32x32x16_bf16 v[80:95], a[240:243], v[136:139], 0
    v_exp_f32 v64, v64
    v_exp_f32 v65, v65
    v_exp_f32 v66, v66
    v_mfma_f32_32x32x16_bf16 v[80:95], a[244:247], v[140:143], v[80:95]
    v_exp_f32 v67, v67
    v_exp_f32 v68, v68
    v_exp_f32 v69, v69
    v_smfmac_f32_32x32x32_bf16 v[112:127], a[188:191], v[56:63], v44
    v_exp_f32 v70, v70
    v_exp_f32 v71, v71
    v_exp_f32 v72, v72
    v_smfmac_f32_16x16x64_bf16 v[132:135], v[40:43], v[56:63], v44
    v_exp_f32 v73, v73
    v_exp_f32 v74, v74
    v_smfmac_f32_32x32x32_bf16 v[96:111], a[232:235], v[64:71], v44
    v_exp_f32 v75, v75
    v_exp_f32 v76, v76
    v_exp_f32 v77, v77
    v_smfmac_f32_16x16x64_bf16 v[128:131], v[40:43], v[64:71], v44
    v_exp_f32 v78, v78
    v_exp_f32 v79, v79
    v_mfma_f32_32x32x16_bf16 v[48:63], a[192:195], v[144:147], 0
    v_exp_f32 v80, v80
    v_exp_f32 v81, v81
    v_exp_f32 v82, v82
    v_mfma_f32_32x32x16_bf16 v[48:63], a[196:199], v[148:151], v[48:63]
    s_waitcnt vmcnt(0)
    v_exp_f32 v83, v83
    v_exp_f32 v84, v84
    v_exp_f32 v85, v85
    v_smfmac_f32_32x32x32_bf16 v[96:111], a[236:239], v[72:79], v44
    v_exp_f32 v86, v86
    v_exp_f32 v87, v87
    v_exp_f32 v88, v88
    v_smfmac_f32_16x16x64_bf16 v[128:131], v[40:43], v[72:79], v44
    buffer_store_dwordx4 v[4:7], v9, s[32:35], 0 offen offset:0 sc1
    v_exp_f32 v89, v89
    v_exp_f32 v90, v90
    v_smfmac_f32_32x32x32_bf16 v[96:111], a[248:251], v[80:87], v44
    v_exp_f32 v91, v91
    v_exp_f32 v92, v92
    v_exp_f32 v93, v93
    v_smfmac_f32_16x16x64_bf16 v[128:131], v[40:43], v[80:87], v44
    buffer_store_dwordx4 v[4:7], v9, s[32:35], 0 offen offset:512 sc1
    v_exp_f32 v94, v94
    v_exp_f32 v95, v95
    v_mfma_f32_32x32x16_bf16 v[64:79], a[208:211], v[144:147], 0
    v_exp_f32 v48, v48
    v_exp_f32 v49, v49
    v_exp_f32 v50, v50
    v_mfma_f32_32x32x16_bf16 v[64:79], a[212:215], v[148:151], v[64:79]
    v_exp_f32 v51, v51
    v_exp_f32 v52, v52
    v_exp_f32 v53, v53
    v_smfmac_f32_32x32x32_bf16 v[96:111], a[252:255], v[88:95], v44
    v_exp_f32 v54, v54
    v_exp_f32 v55, v55
    v_exp_f32 v56, v56
    v_smfmac_f32_16x16x64_bf16 v[128:131], v[40:43], v[88:95], v44
    buffer_store_dwordx4 v[4:7], v47, s[32:35], 0 offen offset:0 sc1
    v_exp_f32 v57, v57
    v_exp_f32 v58, v58
    v_smfmac_f32_32x32x32_bf16 v[112:127], a[200:203], v[48:55], v44
    v_exp_f32 v59, v59
    v_exp_f32 v60, v60
    v_exp_f32 v61, v61
    v_smfmac_f32_16x16x64_bf16 v[132:135], v[40:43], v[48:55], v44
    buffer_store_dwordx4 v[4:7], v47, s[32:35], 0 offen offset:512 sc1
    v_exp_f32 v62, v62
    v_exp_f32 v63, v63
    v_mfma_f32_32x32x16_bf16 v[80:95], a[224:227], v[144:147], 0
    s_mov_b32 m0, s70
    v_exp_f32 v64, v64
    v_exp_f32 v65, v65
    v_exp_f32 v66, v66
    v_mfma_f32_32x32x16_bf16 v[80:95], a[228:231], v[148:151], v[80:95]
    ds_write_b128 v14, v[96:99] offset:17408
    v_exp_f32 v67, v67
    v_exp_f32 v68, v68
    v_exp_f32 v69, v69
    v_smfmac_f32_32x32x32_bf16 v[112:127], a[204:207], v[56:63], v44
    ds_write_b128 v14, v[100:103] offset:18432
    v_exp_f32 v70, v70
    v_exp_f32 v71, v71
    v_exp_f32 v72, v72
    v_smfmac_f32_16x16x64_bf16 v[132:135], v[40:43], v[56:63], v44
    ds_write_b128 v14, v[104:107] offset:19456
    v_exp_f32 v73, v73
    v_exp_f32 v74, v74
    v_smfmac_f32_32x32x32_bf16 v[112:127], a[216:219], v[64:71], v44
    ds_write_addtid_b32 v128 offset:21504
    v_exp_f32 v75, v75
    v_exp_f32 v76, v76
    v_exp_f32 v77, v77
    v_smfmac_f32_16x16x64_bf16 v[132:135], v[40:43], v[64:71], v44
    ds_write_b128 v14, v[108:111] offset:20480
    v_exp_f32 v78, v78
    v_exp_f32 v79, v79
    v_mfma_f32_32x32x16_bf16 v[48:63], a[240:243], v[144:147], 0
    v_exp_f32 v80, v80
    v_exp_f32 v81, v81
    v_exp_f32 v82, v82
    v_mfma_f32_32x32x16_bf16 v[48:63], a[244:247], v[148:151], v[48:63]
    s_waitcnt lgkmcnt(0)
    v_exp_f32 v83, v83
    v_exp_f32 v84, v84
    v_exp_f32 v85, v85
    v_smfmac_f32_32x32x32_bf16 v[112:127], a[220:223], v[72:79], v44
    s_barrier
    v_exp_f32 v86, v86
    v_exp_f32 v87, v87
    v_exp_f32 v88, v88
    v_smfmac_f32_16x16x64_bf16 v[132:135], v[40:43], v[72:79], v44
    ds_read_b128 v[96:99], v15 offset:17408
    v_exp_f32 v89, v89
    v_exp_f32 v90, v90
    v_smfmac_f32_32x32x32_bf16 v[112:127], a[232:235], v[80:87], v44
    ds_read_b32 v128, v8 offset:21504
    v_exp_f32 v91, v91
    v_exp_f32 v92, v92
    v_exp_f32 v93, v93
    v_smfmac_f32_16x16x64_bf16 v[132:135], v[40:43], v[80:87], v44
    ds_read_b128 v[100:103], v15 offset:18432
    v_exp_f32 v94, v94
    v_exp_f32 v95, v95
    v_mfma_f32_32x32x16_bf16 v[64:79], a[0:3], v[152:155], 0
    v_exp_f32 v48, v48
    v_exp_f32 v49, v49
    v_exp_f32 v50, v50
    v_mfma_f32_32x32x16_bf16 v[64:79], a[4:7], v[156:159], v[64:79]
    v_exp_f32 v51, v51
    v_exp_f32 v52, v52
    v_exp_f32 v53, v53
    v_smfmac_f32_32x32x32_bf16 v[112:127], a[236:239], v[88:95], v44
    v_exp_f32 v54, v54
    v_exp_f32 v55, v55
    v_exp_f32 v56, v56
    v_smfmac_f32_16x16x64_bf16 v[132:135], v[40:43], v[88:95], v44
    ds_read_b128 v[104:107], v15 offset:19456
    v_exp_f32 v57, v57
    v_exp_f32 v58, v58
    v_smfmac_f32_32x32x32_bf16 v[112:127], a[248:251], v[48:55], v44
    v_exp_f32 v59, v59
    v_exp_f32 v60, v60
    v_exp_f32 v61, v61
    v_smfmac_f32_16x16x64_bf16 v[132:135], v[40:43], v[48:55], v44
    ds_read_b128 v[108:111], v15 offset:20480
    v_exp_f32 v62, v62
    v_exp_f32 v63, v63
    v_mfma_f32_32x32x16_bf16 v[80:95], a[16:19], v[152:155], 0
    v_exp_f32 v64, v64
    v_exp_f32 v65, v65
    v_exp_f32 v66, v66
    v_mfma_f32_32x32x16_bf16 v[80:95], a[20:23], v[156:159], v[80:95]
    v_exp_f32 v67, v67
    v_exp_f32 v68, v68
    v_exp_f32 v69, v69
    v_smfmac_f32_32x32x32_bf16 v[112:127], a[252:255], v[56:63], v44
    s_waitcnt lgkmcnt(0)
    v_exp_f32 v70, v70
    v_exp_f32 v71, v71
    v_exp_f32 v72, v72
    v_smfmac_f32_16x16x64_bf16 v[132:135], v[40:43], v[56:63], v44
    v_exp_f32 v73, v73
    v_exp_f32 v74, v74
    v_smfmac_f32_32x32x32_bf16 v[96:111], a[8:11], v[64:71], v44
    v_exp_f32 v75, v75
    v_exp_f32 v76, v76
    v_exp_f32 v77, v77
    v_smfmac_f32_16x16x64_bf16 v[128:131], v[40:43], v[64:71], v44
    v_exp_f32 v78, v78
    v_exp_f32 v79, v79
    v_mfma_f32_32x32x16_bf16 v[48:63], a[32:35], v[152:155], 0
    v_exp_f32 v80, v80
    v_exp_f32 v81, v81
    v_exp_f32 v82, v82
    v_mfma_f32_32x32x16_bf16 v[48:63], a[36:39], v[156:159], v[48:63]
    s_mov_b32 m0, s70
    v_exp_f32 v83, v83
    v_exp_f32 v84, v84
    v_exp_f32 v85, v85
    v_smfmac_f32_32x32x32_bf16 v[96:111], a[12:15], v[72:79], v44
    v_exp_f32 v86, v86
    v_exp_f32 v87, v87
    v_exp_f32 v88, v88
    v_smfmac_f32_16x16x64_bf16 v[128:131], v[40:43], v[72:79], v44
    ds_write_addtid_b32 v112 offset:0
    v_exp_f32 v89, v89
    v_exp_f32 v90, v90
    v_smfmac_f32_32x32x32_bf16 v[96:111], a[24:27], v[80:87], v44
    v_exp_f32 v91, v91
    v_exp_f32 v92, v92
    v_exp_f32 v93, v93
    v_smfmac_f32_16x16x64_bf16 v[128:131], v[40:43], v[80:87], v44
    ds_write_addtid_b32 v113 offset:256
    v_exp_f32 v94, v94
    v_exp_f32 v95, v95
    v_mfma_f32_32x32x16_bf16 v[64:79], a[48:51], v[152:155], 0
    v_exp_f32 v48, v48
    v_exp_f32 v49, v49
    v_exp_f32 v50, v50
    v_mfma_f32_32x32x16_bf16 v[64:79], a[52:55], v[156:159], v[64:79]
    v_exp_f32 v51, v51
    v_exp_f32 v52, v52
    v_exp_f32 v53, v53
    v_smfmac_f32_32x32x32_bf16 v[96:111], a[28:31], v[88:95], v44
    v_exp_f32 v54, v54
    v_exp_f32 v55, v55
    v_exp_f32 v56, v56
    v_smfmac_f32_16x16x64_bf16 v[128:131], v[40:43], v[88:95], v44
    ds_write_addtid_b32 v114 offset:512
    v_exp_f32 v57, v57
    v_exp_f32 v58, v58
    v_smfmac_f32_32x32x32_bf16 v[96:111], a[40:43], v[48:55], v44
    v_exp_f32 v59, v59
    v_exp_f32 v60, v60
    v_exp_f32 v61, v61
    v_smfmac_f32_16x16x64_bf16 v[128:131], v[40:43], v[48:55], v44
    ds_write_addtid_b32 v115 offset:768
    v_exp_f32 v62, v62
    v_exp_f32 v63, v63
    v_mfma_f32_32x32x16_bf16 v[80:95], a[64:67], v[152:155], 0
    v_exp_f32 v64, v64
    v_exp_f32 v65, v65
    v_exp_f32 v66, v66
    v_mfma_f32_32x32x16_bf16 v[80:95], a[68:71], v[156:159], v[80:95]
    v_exp_f32 v67, v67
    v_exp_f32 v68, v68
    v_exp_f32 v69, v69
    v_smfmac_f32_32x32x32_bf16 v[96:111], a[44:47], v[56:63], v44
    v_exp_f32 v70, v70
    v_exp_f32 v71, v71
    v_exp_f32 v72, v72
    v_smfmac_f32_16x16x64_bf16 v[128:131], v[40:43], v[56:63], v44
    ds_write_addtid_b32 v116 offset:1024
    v_exp_f32 v73, v73
    v_exp_f32 v74, v74
    v_smfmac_f32_32x32x32_bf16 v[96:111], a[56:59], v[64:71], v44
    v_exp_f32 v75, v75
    v_exp_f32 v76, v76
    v_exp_f32 v77, v77
    v_smfmac_f32_16x16x64_bf16 v[128:131], v[40:43], v[64:71], v44
    ds_write_addtid_b32 v117 offset:1280
    v_exp_f32 v78, v78
    v_exp_f32 v79, v79
    v_mfma_f32_32x32x16_bf16 v[48:63], a[80:83], v[152:155], 0
    v_exp_f32 v80, v80
    v_exp_f32 v81, v81
    v_exp_f32 v82, v82
    v_mfma_f32_32x32x16_bf16 v[48:63], a[84:87], v[156:159], v[48:63]
    v_exp_f32 v83, v83
    v_exp_f32 v84, v84
    v_exp_f32 v85, v85
    v_smfmac_f32_32x32x32_bf16 v[96:111], a[60:63], v[72:79], v44
    v_exp_f32 v86, v86
    v_exp_f32 v87, v87
    v_exp_f32 v88, v88
    v_smfmac_f32_16x16x64_bf16 v[128:131], v[40:43], v[72:79], v44
    ds_write_addtid_b32 v118 offset:1536
    v_exp_f32 v89, v89
    v_exp_f32 v90, v90
    v_smfmac_f32_32x32x32_bf16 v[96:111], a[72:75], v[80:87], v44
    v_exp_f32 v91, v91
    v_exp_f32 v92, v92
    v_exp_f32 v93, v93
    v_smfmac_f32_16x16x64_bf16 v[128:131], v[40:43], v[80:87], v44
    ds_write_addtid_b32 v119 offset:1792
    v_exp_f32 v94, v94
    v_exp_f32 v95, v95
    v_mfma_f32_32x32x16_bf16 v[64:79], a[96:99], v[152:155], 0
    v_exp_f32 v48, v48
    v_exp_f32 v49, v49
    v_exp_f32 v50, v50
    v_mfma_f32_32x32x16_bf16 v[64:79], a[100:103], v[156:159], v[64:79]
    v_exp_f32 v51, v51
    v_exp_f32 v52, v52
    v_exp_f32 v53, v53
    v_smfmac_f32_32x32x32_bf16 v[96:111], a[76:79], v[88:95], v44
    v_exp_f32 v54, v54
    v_exp_f32 v55, v55
    v_exp_f32 v56, v56
    v_smfmac_f32_16x16x64_bf16 v[128:131], v[40:43], v[88:95], v44
    ds_write_addtid_b32 v120 offset:2048
    v_exp_f32 v57, v57
    v_exp_f32 v58, v58
    v_smfmac_f32_32x32x32_bf16 v[96:111], a[88:91], v[48:55], v44
    v_exp_f32 v59, v59
    v_exp_f32 v60, v60
    v_exp_f32 v61, v61
    v_smfmac_f32_16x16x64_bf16 v[128:131], v[40:43], v[48:55], v44
    ds_write_addtid_b32 v121 offset:2304
    v_exp_f32 v62, v62
    v_exp_f32 v63, v63
    v_mfma_f32_32x32x16_bf16 v[80:95], a[112:115], v[152:155], 0
    v_exp_f32 v64, v64
    v_exp_f32 v65, v65
    v_exp_f32 v66, v66
    v_mfma_f32_32x32x16_bf16 v[80:95], a[116:119], v[156:159], v[80:95]
    v_exp_f32 v67, v67
    v_exp_f32 v68, v68
    v_exp_f32 v69, v69
    v_smfmac_f32_32x32x32_bf16 v[96:111], a[92:95], v[56:63], v44
    v_exp_f32 v70, v70
    v_exp_f32 v71, v71
    v_exp_f32 v72, v72
    v_smfmac_f32_16x16x64_bf16 v[128:131], v[40:43], v[56:63], v44
    ds_write_addtid_b32 v122 offset:2560
    v_exp_f32 v73, v73
    v_exp_f32 v74, v74
    v_smfmac_f32_32x32x32_bf16 v[96:111], a[104:107], v[64:71], v44
    v_exp_f32 v75, v75
    v_exp_f32 v76, v76
    v_exp_f32 v77, v77
    v_smfmac_f32_16x16x64_bf16 v[128:131], v[40:43], v[64:71], v44
    ds_write_addtid_b32 v123 offset:2816
    v_exp_f32 v78, v78
    v_exp_f32 v79, v79
    v_mfma_f32_32x32x16_bf16 v[48:63], a[128:131], v[152:155], 0
    v_exp_f32 v80, v80
    v_exp_f32 v81, v81
    v_exp_f32 v82, v82
    v_mfma_f32_32x32x16_bf16 v[48:63], a[132:135], v[156:159], v[48:63]
    v_exp_f32 v83, v83
    v_exp_f32 v84, v84
    v_exp_f32 v85, v85
    v_smfmac_f32_32x32x32_bf16 v[96:111], a[108:111], v[72:79], v44
    v_exp_f32 v86, v86
    v_exp_f32 v87, v87
    v_exp_f32 v88, v88
    v_smfmac_f32_16x16x64_bf16 v[128:131], v[40:43], v[72:79], v44
    ds_write_addtid_b32 v124 offset:3072
    v_exp_f32 v89, v89
    v_exp_f32 v90, v90
    v_smfmac_f32_32x32x32_bf16 v[96:111], a[120:123], v[80:87], v44
    v_exp_f32 v91, v91
    v_exp_f32 v92, v92
    v_exp_f32 v93, v93
    v_smfmac_f32_16x16x64_bf16 v[128:131], v[40:43], v[80:87], v44
    ds_write_addtid_b32 v125 offset:3328
    v_exp_f32 v94, v94
    v_exp_f32 v95, v95
    v_mfma_f32_32x32x16_bf16 v[64:79], a[144:147], v[152:155], 0
    s_sub_u32 m0, s68, 0
    v_exp_f32 v48, v48
    v_exp_f32 v49, v49
    v_exp_f32 v50, v50
    v_mfma_f32_32x32x16_bf16 v[64:79], a[148:151], v[156:159], v[64:79]
    v_exp_f32 v51, v51
    v_exp_f32 v52, v52
    v_exp_f32 v53, v53
    v_smfmac_f32_32x32x32_bf16 v[96:111], a[124:127], v[88:95], v44
    buffer_load_dwordx4 v32, s[16:19], 0 offen offset:0 lds
    v_exp_f32 v54, v54
    v_exp_f32 v55, v55
    v_exp_f32 v56, v56
    v_smfmac_f32_16x16x64_bf16 v[128:131], v[40:43], v[88:95], v44
    buffer_load_dwordx4 v33, s[16:19], 0 offen offset:1024 lds
    v_exp_f32 v57, v57
    v_exp_f32 v58, v58
    v_smfmac_f32_32x32x32_bf16 v[96:111], a[136:139], v[48:55], v44
    buffer_load_dwordx4 v34, s[16:19], 0 offen offset:2048 lds
    v_exp_f32 v59, v59
    v_exp_f32 v60, v60
    v_exp_f32 v61, v61
    v_smfmac_f32_16x16x64_bf16 v[128:131], v[40:43], v[48:55], v44
    buffer_load_dwordx4 v35, s[16:19], 0 offen offset:3072 lds
    v_exp_f32 v62, v62
    v_exp_f32 v63, v63
    v_mfma_f32_32x32x16_bf16 v[80:95], a[160:163], v[152:155], 0
    v_exp_f32 v64, v64
    v_exp_f32 v65, v65
    v_exp_f32 v66, v66
    v_mfma_f32_32x32x16_bf16 v[80:95], a[164:167], v[156:159], v[80:95]
    s_mov_b32 m0, s70
    v_exp_f32 v67, v67
    v_exp_f32 v68, v68
    v_exp_f32 v69, v69
    v_smfmac_f32_32x32x32_bf16 v[96:111], a[140:143], v[56:63], v44
    v_exp_f32 v70, v70
    v_exp_f32 v71, v71
    v_exp_f32 v72, v72
    v_smfmac_f32_16x16x64_bf16 v[128:131], v[40:43], v[56:63], v44
L_pad3:
    s_cbranch_execz L_padback
    ds_write_addtid_b32 v126 offset:3584
    v_exp_f32 v73, v73
    v_exp_f32 v74, v74
    v_smfmac_f32_32x32x32_bf16 v[96:111], a[152:155], v[64:71], v44
    v_exp_f32 v75, v75
    v_exp_f32 v76, v76
    v_exp_f32 v77, v77
    v_smfmac_f32_16x16x64_bf16 v[128:131], v[40:43], v[64:71], v44
    ds_write_addtid_b32 v127 offset:3840
    v_exp_f32 v78, v78
    v_exp_f32 v79, v79
    v_mfma_f32_32x32x16_bf16 v[48:63], a[176:179], v[152:155], 0
    v_exp_f32 v80, v80
    v_exp_f32 v81, v81
    v_exp_f32 v82, v82
    v_mfma_f32_32x32x16_bf16 v[48:63], a[180:183], v[156:159], v[48:63]
    v_exp_f32 v83, v83
    v_exp_f32 v84, v84
    v_exp_f32 v85, v85
    v_smfmac_f32_32x32x32_bf16 v[96:111], a[156:159], v[72:79], v44
    v_exp_f32 v86, v86
    v_exp_f32 v87, v87
    v_exp_f32 v88, v88
    v_smfmac_f32_16x16x64_bf16 v[128:131], v[40:43], v[72:79], v44
    ds_write_addtid_b32 v132 offset:4096
    v_exp_f32 v89, v89
    v_exp_f32 v90, v90
    v_smfmac_f32_32x32x32_bf16 v[96:111], a[168:171], v[80:87], v44
    v_exp_f32 v91, v91
    v_exp_f32 v92, v92
    v_exp_f32 v93, v93
    v_smfmac_f32_16x16x64_bf16 v[128:131], v[40:43], v[80:87], v44
    v_exp_f32 v94, v94
    v_exp_f32 v95, v95
    v_mfma_f32_32x32x16_bf16 v[64:79], a[192:195], v[152:155], 0
    v_exp_f32 v48, v48
    v_exp_f32 v49, v49
    v_exp_f32 v50, v50
    v_mfma_f32_32x32x16_bf16 v[64:79], a[196:199], v[156:159], v[64:79]
    s_waitcnt lgkmcnt(0)
    v_exp_f32 v51, v51
    v_exp_f32 v52, v52
    v_exp_f32 v53, v53
    v_smfmac_f32_32x32x32_bf16 v[96:111], a[172:175], v[88:95], v44
    s_barrier
    v_exp_f32 v54, v54
    v_exp_f32 v55, v55
    v_exp_f32 v56, v56
    v_smfmac_f32_16x16x64_bf16 v[128:131], v[40:43], v[88:95], v44
    ds_read2st64_b32 v[112:113], v8 offset0:0 offset1:1
    v_exp_f32 v57, v57
    v_exp_f32 v58, v58
    v_smfmac_f32_32x32x32_bf16 v[96:111], a[184:187], v[48:55], v44
    v_exp_f32 v59, v59
    v_exp_f32 v60, v60
    v_exp_f32 v61, v61
    v_smfmac_f32_16x16x64_bf16 v[128:131], v[40:43], v[48:55], v44
    ds_read2st64_b32 v[114:115], v8 offset0:2 offset1:3
    v_exp_f32 v62, v62
    v_exp_f32 v63, v63
    v_mfma_f32_32x32x16_bf16 v[80:95], a[208:211], v[152:155], 0
    v_exp_f32 v64, v64
    v_exp_f32 v65, v65
    v_exp_f32 v66, v66
    v_mfma_f32_32x32x16_bf16 v[80:95], a[212:215], v[156:159], v[80:95]
    v_exp_f32 v67, v67
    v_exp_f32 v68, v68
    v_exp_f32 v69, v69
    v_smfmac_f32_32x32x32_bf16 v[96:111], a[188:191], v[56:63], v44
    v_exp_f32 v70, v70
    v_exp_f32 v71, v71
    v_exp_f32 v72, v72
    v_smfmac_f32_16x16x64_bf16 v[128:131], v[40:43], v[56:63], v44
    ds_read2st64_b32 v[116:117], v8 offset0:4 offset1:5
    v_exp_f32 v73, v73
    v_exp_f32 v74, v74
    v_smfmac_f32_32x32x32_bf16 v[96:111], a[200:203], v[64:71], v44
    v_exp_f32 v75, v75
    v_exp_f32 v76, v76
    v_exp_f32 v77, v77
    v_smfmac_f32_16x16x64_bf16 v[128:131], v[40:43], v[64:71], v44
    ds_read2st64_b32 v[118:119], v8 offset0:6 offset1:7
    v_exp_f32 v78, v78
    v_exp_f32 v79, v79
    v_mfma_f32_32x32x16_bf16 v[48:63], a[224:227], v[152:155], 0
    v_exp_f32 v80, v80
    v_exp_f32 v81, v81
    v_exp_f32 v82, v82
    v_mfma_f32_32x32x16_bf16 v[48:63], a[228:231], v[156:159], v[48:63]
    v_exp_f32 v83, v83
    v_exp_f32 v84, v84
    v_exp_f32 v85, v85
    v_smfmac_f32_32x32x32_bf16 v[96:111], a[204:207], v[72:79], v44
    v_exp_f32 v86, v86
    v_exp_f32 v87, v87
    v_exp_f32 v88, v88
    v_smfmac_f32_16x16x64_bf16 v[128:131], v[40:43], v[72:79], v44
    ds_read2st64_b32 v[120:121], v8 offset0:8 offset1:9
    v_exp_f32 v89, v89
    v_exp_f32 v90, v90
    v_smfmac_f32_32x32x32_bf16 v[96:111], a[216:219], v[80:87], v44
    v_exp_f32 v91, v91
    v_exp_f32 v92, v92
    v_exp_f32 v93, v93
    v_smfmac_f32_16x16x64_bf16 v[128:131], v[40:43], v[80:87], v44
    ds_read2st64_b32 v[122:123], v8 offset0:10 offset1:11
    v_exp_f32 v94, v94
    v_exp_f32 v95, v95
    v_mfma_f32_32x32x16_bf16 v[64:79], a[240:243], v[152:155], 0
    v_exp_f32 v48, v48
    v_exp_f32 v49, v49
    v_exp_f32 v50, v50
    v_mfma_f32_32x32x16_bf16 v[64:79], a[244:247], v[156:159], v[64:79]
    v_exp_f32 v51, v51
    v_exp_f32 v52, v52
    v_exp_f32 v53, v53
    v_smfmac_f32_32x32x32_bf16 v[96:111], a[220:223], v[88:95], v44
    v_exp_f32 v54, v54
    v_exp_f32 v55, v55
    v_exp_f32 v56, v56
    v_smfmac_f32_16x16x64_bf16 v[128:131], v[40:43], v[88:95], v44
    ds_read2st64_b32 v[124:125], v8 offset0:12 offset1:13
    v_exp_f32 v57, v57
    v_exp_f32 v58, v58
    v_smfmac_f32_32x32x32_bf16 v[96:111], a[232:235], v[48:55], v44
    v_exp_f32 v59, v59
    v_exp_f32 v60, v60
    v_exp_f32 v61, v61
    v_smfmac_f32_16x16x64_bf16 v[128:131], v[40:43], v[48:55], v44
    ds_read2st64_b32 v[126:127], v8 offset0:14 offset1:15
    v_exp_f32 v62, v62
    v_exp_f32 v63, v63
    v_mfma_f32_32x32x16_bf16 v[80:95], a[0:3], v[160:163], 0
    v_exp_f32 v64, v64
    v_exp_f32 v65, v65
    v_exp_f32 v66, v66
    v_mfma_f32_32x32x16_bf16 v[80:95], a[4:7], v[164:167], v[80:95]
    v_exp_f32 v67, v67
    v_exp_f32 v68, v68
    v_exp_f32 v69, v69
    v_smfmac_f32_32x32x32_bf16 v[96:111], a[236:239], v[56:63], v44
    v_exp_f32 v70, v70
    v_exp_f32 v71, v71
    v_exp_f32 v72, v72
    v_smfmac_f32_16x16x64_bf16 v[128:131], v[40:43], v[56:63], v44
    ds_read_b32 v132, v8 offset:4096
    v_exp_f32 v73, v73
    v_exp_f32 v74, v74
    v_smfmac_f32_32x32x32_bf16 v[96:111], a[248:251], v[64:71], v44
    s_add_u32 s16, s16, 524288
    s_addc_u32 s17, s17, 0
    v_exp_f32 v75, v75
    v_exp_f32 v76, v76
    v_exp_f32 v77, v77
    v_smfmac_f32_16x16x64_bf16 v[128:131], v[40:43], v[64:71], v44
    v_exp_f32 v78, v78
    v_exp_f32 v79, v79
    v_mfma_f32_32x32x16_bf16 v[48:63], a[16:19], v[160:163], 0
    s_sub_u32 m0, s68, 16384
    v_exp_f32 v80, v80
    v_exp_f32 v81, v81
    v_exp_f32 v82, v82
    v_mfma_f32_32x32x16_bf16 v[48:63], a[20:23], v[164:167], v[48:63]
    s_waitcnt lgkmcnt(0)
    v_exp_f32 v83, v83
    v_exp_f32 v84, v84
    v_exp_f32 v85, v85
    v_smfmac_f32_32x32x32_bf16 v[96:111], a[252:255], v[72:79], v44
    buffer_load_dwordx4 v32, s[16:19], 0 offen offset:0 lds
    v_exp_f32 v86, v86
    v_exp_f32 v87, v87
    v_exp_f32 v88, v88
    v_smfmac_f32_16x16x64_bf16 v[128:131], v[40:43], v[72:79], v44
    buffer_load_dwordx4 v33, s[16:19], 0 offen offset:1024 lds
    v_exp_f32 v89, v89
    v_exp_f32 v90, v90
    v_smfmac_f32_32x32x32_bf16 v[112:127], a[8:11], v[80:87], v44
    buffer_load_dwordx4 v34, s[16:19], 0 offen offset:2048 lds
    v_exp_f32 v91, v91
    v_exp_f32 v92, v92
    v_exp_f32 v93, v93
    v_smfmac_f32_16x16x64_bf16 v[132:135], v[40:43], v[80:87], v44
    buffer_load_dwordx4 v35, s[16:19], 0 offen offset:3072 lds
    v_exp_f32 v94, v94
    v_exp_f32 v95, v95
    v_mfma_f32_32x32x16_bf16 v[64:79], a[32:35], v[160:163], 0
    v_exp_f32 v48, v48
    v_exp_f32 v49, v49
    v_exp_f32 v50, v50
    v_mfma_f32_32x32x16_bf16 v[64:79], a[36:39], v[164:167], v[64:79]
    s_mov_b32 m0, s70
    v_exp_f32 v51, v51
    v_exp_f32 v52, v52
    v_exp_f32 v53, v53
    v_smfmac_f32_32x32x32_bf16 v[112:127], a[12:15], v[88:95], v44
    v_exp_f32 v54, v54
    v_exp_f32 v55, v55
    v_exp_f32 v56, v56
    v_smfmac_f32_16x16x64_bf16 v[132:135], v[40:43], v[88:95], v44
    ds_write_addtid_b32 v96 offset:17408
    v_exp_f32 v57, v57
    v_exp_f32 v58, v58
    v_smfmac_f32_32x32x32_bf16 v[112:127], a[24:27], v[48:55], v44
    v_exp_f32 v59, v59
    v_exp_f32 v60, v60
    v_exp_f32 v61, v61
    v_smfmac_f32_16x16x64_bf16 v[132:135], v[40:43], v[48:55], v44
    ds_write_addtid_b32 v97 offset:17664
    v_exp_f32 v62, v62
    v_exp_f32 v63, v63
    v_mfma_f32_32x32x16_bf16 v[80:95], a[48:51], v[160:163], 0
    v_exp_f32 v64, v64
    v_exp_f32 v65, v65
    v_exp_f32 v66, v66
    v_mfma_f32_32x32x16_bf16 v[80:95], a[52:55], v[164:167], v[80:95]
    v_exp_f32 v67, v67
    v_exp_f32 v68, v68
    v_exp_f32 v69, v69
    v_smfmac_f32_32x32x32_bf16 v[112:127], a[28:31], v[56:63], v44
    v_exp_f32 v70, v70
    v_exp_f32 v71, v71
    v_exp_f32 v72, v72
    v_smfmac_f32_16x16x64_bf16 v[132:135], v[40:43], v[56:63], v44
    ds_write_addtid_b32 v98 offset:17920
    v_exp_f32 v73, v73
    v_exp_f32 v74, v74
    v_smfmac_f32_32x32x32_bf16 v[112:127], a[40:43], v[64:71], v44
    v_exp_f32 v75, v75
    v_exp_f32 v76, v76
    v_exp_f32 v77, v77
    v_smfmac_f32_16x16x64_bf16 v[132:135], v[40:43], v[64:71], v44
    ds_write_addtid_b32 v99 offset:18176
    v_exp_f32 v78, v78
    v_exp_f32 v79, v79
    v_mfma_f32_32x32x16_bf16 v[48:63], a[64:67], v[160:163], 0
    v_exp_f32 v80, v80
    v_exp_f32 v81, v81
    v_exp_f32 v82, v82
    v_mfma_f32_32x32x16_bf16 v[48:63], a[68:71], v[164:167], v[48:63]
    v_exp_f32 v83, v83
    v_exp_f32 v84, v84
    v_exp_f32 v85, v85
    v_smfmac_f32_32x32x32_bf16 v[112:127], a[44:47], v[72:79], v44
    v_exp_f32 v86, v86
    v_exp_f32 v87, v87
    v_exp_f32 v88, v88
    v_smfmac_f32_16x16x64_bf16 v[132:135], v[40:43], v[72:79], v44
    ds_write_addtid_b32 v100 offset:18432
    v_exp_f32 v89, v89
    v_exp_f32 v90, v90
    v_smfmac_f32_32x32x32_bf16 v[112:127], a[56:59], v[80:87], v44
    v_exp_f32 v91, v91
    v_exp_f32 v92, v92
    v_exp_f32 v93, v93
    v_smfmac_f32_16x16x64_bf16 v[132:135], v[40:43], v[80:87], v44
    ds_write_addtid_b32 v101 offset:18688
    v_exp_f32 v94, v94
    v_exp_f32 v95, v95
    v_mfma_f32_32x32x16_bf16 v[64:79], a[80:83], v[160:163], 0
    v_exp_f32 v48, v48
    v_exp_f32 v49, v49
    v_exp_f32 v50, v50
    v_mfma_f32_32x32x16_bf16 v[64:79], a[84:87], v[164:167], v[64:79]
    v_exp_f32 v51, v51
    v_exp_f32 v52, v52
    v_exp_f32 v53, v53
    v_smfmac_f32_32x32x32_bf16 v[112:127], a[60:63], v[88:95], v44
    v_exp_f32 v54, v54
    v_exp_f32 v55, v55
    v_exp_f32 v56, v56
    v_smfmac_f32_16x16x64_bf16 v[132:135], v[40:43], v[88:95], v44
    ds_write_addtid_b32 v102 offset:18944
    v_exp_f32 v57, v57
    v_exp_f32 v58, v58
    v_smfmac_f32_32x32x32_bf16 v[112:127], a[72:75], v[48:55], v44
    v_exp_f32 v59, v59
    v_exp_f32 v60, v60
    v_exp_f32 v61, v61
    v_smfmac_f32_16x16x64_bf16 v[132:135], v[40:43], v[48:55], v44
    ds_write_addtid_b32 v103 offset:19200
    v_exp_f32 v62, v62
    v_exp_f32 v63, v63
    v_mfma_f32_32x32x16_bf16 v[80:95], a[96:99], v[160:163], 0
    v_exp_f32 v64, v64
    v_exp_f32 v65, v65
    v_exp_f32 v66, v66
    v_mfma_f32_32x32x16_bf16 v[80:95], a[100:103], v[164:167], v[80:95]
    v_exp_f32 v67, v67
    v_exp_f32 v68, v68
    v_exp_f32 v69, v69
    v_smfmac_f32_32x32x32_bf16 v[112:127], a[76:79], v[56:63], v44
    v_exp_f32 v70, v70
    v_exp_f32 v71, v71
    v_exp_f32 v72, v72
    v_smfmac_f32_16x16x64_bf16 v[132:135], v[40:43], v[56:63], v44
    ds_write_addtid_b32 v104 offset:19456
    v_exp_f32 v73, v73
    v_exp_f32 v74, v74
    v_smfmac_f32_32x32x32_bf16 v[112:127], a[88:91], v[64:71], v44
    v_exp_f32 v75, v75
    v_exp_f32 v76, v76
    v_exp_f32 v77, v77
    v_smfmac_f32_16x16x64_bf16 v[132:135], v[40:43], v[64:71], v44
    ds_write_addtid_b32 v105 offset:19712
    v_exp_f32 v78, v78
    v_exp_f32 v79, v79
    v_mfma_f32_32x32x16_bf16 v[48:63], a[112:115], v[160:163], 0
    v_exp_f32 v80, v80
    v_exp_f32 v81, v81
    v_exp_f32 v82, v82
    v_mfma_f32_32x32x16_bf16 v[48:63], a[116:119], v[164:167], v[48:63]
    v_exp_f32 v83, v83
    v_exp_f32 v84, v84
    v_exp_f32 v85, v85
    v_smfmac_f32_32x32x32_bf16 v[112:127], a[92:95], v[72:79], v44
    v_exp_f32 v86, v86
    v_exp_f32 v87, v87
    v_exp_f32 v88, v88
    v_smfmac_f32_16x16x64_bf16 v[132:135], v[40:43], v[72:79], v44
    ds_write_addtid_b32 v106 offset:19968
    v_exp_f32 v89, v89
    v_exp_f32 v90, v90
    v_smfmac_f32_32x32x32_bf16 v[112:127], a[104:107], v[80:87], v44
    v_exp_f32 v91, v91
    v_exp_f32 v92, v92
    v_exp_f32 v93, v93
    v_smfmac_f32_16x16x64_bf16 v[132:135], v[40:43], v[80:87], v44
    ds_write_addtid_b32 v107 offset:20224
    v_exp_f32 v94, v94
    v_exp_f32 v95, v95
    v_mfma_f32_32x32x16_bf16 v[64:79], a[128:131], v[160:163], 0
    v_exp_f32 v48, v48
    v_exp_f32 v49, v49
    v_exp_f32 v50, v50
    v_mfma_f32_32x32x16_bf16 v[64:79], a[132:135], v[164:167], v[64:79]
    v_exp_f32 v51, v51
    v_exp_f32 v52, v52
    v_exp_f32 v53, v53
    v_smfmac_f32_32x32x32_bf16 v[112:127], a[108:111], v[88:95], v44
    v_exp_f32 v54, v54
    v_exp_f32 v55, v55
    v_exp_f32 v56, v56
    v_smfmac_f32_16x16x64_bf16 v[132:135], v[40:43], v[88:95], v44
    ds_write_addtid_b32 v108 offset:20480
    v_exp_f32 v57, v57
    v_exp_f32 v58, v58
    v_smfmac_f32_32x32x32_bf16 v[112:127], a[120:123], v[48:55], v44
    s_add_u32 s16, s16, 524288
    s_addc_u32 s17, s17, 0
    v_exp_f32 v59, v59
    v_exp_f32 v60, v60
    v_exp_f32 v61, v61
    v_smfmac_f32_16x16x64_bf16 v[132:135], v[40:43], v[48:55], v44
    ds_write_addtid_b32 v109 offset:20736
    v_exp_f32 v62, v62
    v_exp_f32 v63, v63
    v_mfma_f32_32x32x16_bf16 v[80:95], a[144:147], v[160:163], 0
    s_sub_u32 m0, s68, 32768
    v_exp_f32 v64, v64
    v_exp_f32 v65, v65
    v_exp_f32 v66, v66
    v_mfma_f32_32x32x16_bf16 v[80:95], a[148:151], v[164:167], v[80:95]
    v_exp_f32 v67, v67
    v_exp_f32 v68, v68
    v_exp_f32 v69, v69
    v_smfmac_f32_32x32x32_bf16 v[112:127], a[124:127], v[56:63], v44
    buffer_load_dwordx4 v32, s[16:19], 0 offen offset:0 lds
    v_exp_f32 v70, v70
    v_exp_f32 v71, v71
    v_exp_f32 v72, v72
    v_smfmac_f32_16x16x64_bf16 v[132:135], v[40:43], v[56:63], v44
    buffer_load_dwordx4 v33, s[16:19], 0 offen offset:1024 lds
    v_exp_f32 v73, v73
    v_exp_f32 v74, v74
    v_smfmac_f32_32x32x32_bf16 v[112:127], a[136:139], v[64:71], v44
    buffer_load_dwordx4 v34, s[16:19], 0 offen offset:2048 lds
    v_exp_f32 v75, v75
    v_exp_f32 v76, v76
    v_exp_f32 v77, v77
    v_smfmac_f32_16x16x64_bf16 v[132:135], v[40:43], v[64:71], v44
    buffer_load_dwordx4 v35, s[16:19], 0 offen offset:3072 lds
    v_exp_f32 v78, v78
    v_exp_f32 v79, v79
    v_mfma_f32_32x32x16_bf16 v[48:63], a[160:163], v[160:163], 0
    v_exp_f32 v80, v80
    v_exp_f32 v81, v81
    v_exp_f32 v82, v82
    v_mfma_f32_32x32x16_bf16 v[48:63], a[164:167], v[164:167], v[48:63]
    s_mov_b32 m0, s70
    v_exp_f32 v83, v83
    v_exp_f32 v84, v84
    v_exp_f32 v85, v85
    v_smfmac_f32_32x32x32_bf16 v[112:127], a[140:143], v[72:79], v44
    v_exp_f32 v86, v86
    v_exp_f32 v87, v87
    v_exp_f32 v88, v88
    v_smfmac_f32_16x16x64_bf16 v[132:135], v[40:43], v[72:79], v44
    ds_write_addtid_b32 v110 offset:20992
    v_exp_f32 v89, v89
    v_exp_f32 v90, v90
    v_smfmac_f32_32x32x32_bf16 v[112:127], a[152:155], v[80:87], v44
    v_exp_f32 v91, v91
    v_exp_f32 v92, v92
    v_exp_f32 v93, v93
    v_smfmac_f32_16x16x64_bf16 v[132:135], v[40:43], v[80:87], v44
    ds_write_addtid_b32 v111 offset:21248
    v_exp_f32 v94, v94
    v_exp_f32 v95, v95
    v_mfma_f32_32x32x16_bf16 v[64:79], a[176:179], v[160:163], 0
    v_exp_f32 v48, v48
    v_exp_f32 v49, v49
    v_exp_f32 v50, v50
    v_mfma_f32_32x32x16_bf16 v[64:79], a[180:183], v[164:167], v[64:79]
    v_exp_f32 v51, v51
    v_exp_f32 v52, v52
    v_exp_f32 v53, v53
    v_smfmac_f32_32x32x32_bf16 v[112:127], a[156:159], v[88:95], v44
    v_exp_f32 v54, v54
    v_exp_f32 v55, v55
    v_exp_f32 v56, v56
    v_smfmac_f32_16x16x64_bf16 v[132:135], v[40:43], v[88:95], v44
    ds_write_addtid_b32 v128 offset:21504
    v_exp_f32 v57, v57
    v_exp_f32 v58, v58
    v_smfmac_f32_32x32x32_bf16 v[112:127], a[168:171], v[48:55], v44
    v_exp_f32 v59, v59
    v_exp_f32 v60, v60
    v_exp_f32 v61, v61
    v_smfmac_f32_16x16x64_bf16 v[132:135], v[40:43], v[48:55], v44
    v_exp_f32 v62, v62
    v_exp_f32 v63, v63
    v_mfma_f32_32x32x16_bf16 v[80:95], a[192:195], v[160:163], 0
    s_waitcnt vmcnt(12)
    v_exp_f32 v64, v64
    v_exp_f32 v65, v65
    v_exp_f32 v66, v66
    v_mfma_f32_32x32x16_bf16 v[80:95], a[196:199], v[164:167], v[80:95]
    s_waitcnt lgkmcnt(0)
    v_exp_f32 v67, v67
    v_exp_f32 v68, v68
    v_exp_f32 v69, v69
    v_smfmac_f32_32x32x32_bf16 v[112:127], a[172:175], v[56:63], v44
    s_barrier
    v_exp_f32 v70, v70
    v_exp_f32 v71, v71
    v_exp_f32 v72, v72
    v_smfmac_f32_16x16x64_bf16 v[132:135], v[40:43], v[56:63], v44
    ds_read2st64_b32 v[96:97], v8 offset0:68 offset1:69
    v_exp_f32 v73, v73
    v_exp_f32 v74, v74
    v_smfmac_f32_32x32x32_bf16 v[112:127], a[184:187], v[64:71], v44
    v_exp_f32 v75, v75
    v_exp_f32 v76, v76
    v_exp_f32 v77, v77
    v_smfmac_f32_16x16x64_bf16 v[132:135], v[40:43], v[64:71], v44
    ds_read2st64_b32 v[98:99], v8 offset0:70 offset1:71
    v_exp_f32 v78, v78
    v_exp_f32 v79, v79
    v_mfma_f32_32x32x16_bf16 v[48:63], a[208:211], v[160:163], 0
    v_exp_f32 v80, v80
    v_exp_f32 v81, v81
    v_exp_f32 v82, v82
    v_mfma_f32_32x32x16_bf16 v[48:63], a[212:215], v[164:167], v[48:63]
    v_exp_f32 v83, v83
    v_exp_f32 v84, v84
    v_exp_f32 v85, v85
    v_smfmac_f32_32x32x32_bf16 v[112:127], a[188:191], v[72:79], v44
    v_exp_f32 v86, v86
    v_exp_f32 v87, v87
    v_exp_f32 v88, v88
    v_smfmac_f32_16x16x64_bf16 v[132:135], v[40:43], v[72:79], v44
    ds_read2st64_b32 v[100:101], v8 offset0:72 offset1:73
    v_exp_f32 v89, v89
    v_exp_f32 v90, v90
    v_smfmac_f32_32x32x32_bf16 v[112:127], a[200:203], v[80:87], v44
    v_exp_f32 v91, v91
    v_exp_f32 v92, v92
    v_exp_f32 v93, v93
    v_smfmac_f32_16x16x64_bf16 v[132:135], v[40:43], v[80:87], v44
    ds_read2st64_b32 v[102:103], v8 offset0:74 offset1:75
    v_exp_f32 v94, v94
    v_exp_f32 v95, v95
    v_mfma_f32_32x32x16_bf16 v[64:79], a[224:227], v[160:163], 0
    v_exp_f32 v48, v48
    v_exp_f32 v49, v49
    v_exp_f32 v50, v50
    v_mfma_f32_32x32x16_bf16 v[64:79], a[228:231], v[164:167], v[64:79]
    v_exp_f32 v51, v51
    v_exp_f32 v52, v52
    v_exp_f32 v53, v53
    v_smfmac_f32_32x32x32_bf16 v[112:127], a[204:207], v[88:95], v44
    v_exp_f32 v54, v54
    v_exp_f32 v55, v55
    v_exp_f32 v56, v56
    v_smfmac_f32_16x16x64_bf16 v[132:135], v[40:43], v[88:95], v44
    ds_read2st64_b32 v[104:105], v8 offset0:76 offset1:77
    v_exp_f32 v57, v57
    v_exp_f32 v58, v58
    v_smfmac_f32_32x32x32_bf16 v[112:127], a[216:219], v[48:55], v44
    v_exp_f32 v59, v59
    v_exp_f32 v60, v60
    v_exp_f32 v61, v61
    v_smfmac_f32_16x16x64_bf16 v[132:135], v[40:43], v[48:55], v44
    ds_read2st64_b32 v[106:107], v8 offset0:78 offset1:79
    v_exp_f32 v62, v62
    v_exp_f32 v63, v63
    v_mfma_f32_32x32x16_bf16 v[80:95], a[240:243], v[160:163], 0
    v_exp_f32 v64, v64
    v_exp_f32 v65, v65
    v_exp_f32 v66, v66
    v_mfma_f32_32x32x16_bf16 v[80:95], a[244:247], v[164:167], v[80:95]
    v_exp_f32 v67, v67
    v_exp_f32 v68, v68
    v_exp_f32 v69, v69
    v_smfmac_f32_32x32x32_bf16 v[112:127], a[220:223], v[56:63], v44
    v_exp_f32 v70, v70
    v_exp_f32 v71, v71
    v_exp_f32 v72, v72
    v_smfmac_f32_16x16x64_bf16 v[132:135], v[40:43], v[56:63], v44
    ds_read2st64_b32 v[108:109], v8 offset0:80 offset1:81
    v_exp_f32 v73, v73
    v_exp_f32 v74, v74
    v_smfmac_f32_32x32x32_bf16 v[112:127], a[232:235], v[64:71], v44
    v_exp_f32 v75, v75
    v_exp_f32 v76, v76
    v_exp_f32 v77, v77
    v_smfmac_f32_16x16x64_bf16 v[132:135], v[40:43], v[64:71], v44
    ds_read2st64_b32 v[110:111], v8 offset0:82 offset1:83
    v_exp_f32 v78, v78
    v_exp_f32 v79, v79
    v_mfma_f32_32x32x16_bf16 v[48:63], a[0:3], v[168:171], 0
    v_exp_f32 v80, v80
    v_exp_f32 v81, v81
    v_exp_f32 v82, v82
    v_mfma_f32_32x32x16_bf16 v[48:63], a[4:7], v[172:175], v[48:63]
    v_exp_f32 v83, v83
    v_exp_f32 v84, v84
    v_exp_f32 v85, v85
    v_smfmac_f32_32x32x32_bf16 v[112:127], a[236:239], v[72:79], v44
    v_exp_f32 v86, v86
    v_exp_f32 v87, v87
    v_exp_f32 v88, v88
    v_smfmac_f32_16x16x64_bf16 v[132:135], v[40:43], v[72:79], v44
    ds_read_b32 v128, v8 offset:21504
    v_exp_f32 v89, v89
    v_exp_f32 v90, v90
    v_smfmac_f32_32x32x32_bf16 v[112:127], a[248:251], v[80:87], v44
    s_add_u32 s16, s16, 524288
    s_addc_u32 s17, s17, 0
    v_exp_f32 v91, v91
    v_exp_f32 v92, v92
    v_exp_f32 v93, v93
    v_smfmac_f32_16x16x64_bf16 v[132:135], v[40:43], v[80:87], v44
    buffer_store_dword v3, v2, s[24:27], 0 offen offset:4 sc1
    v_exp_f32 v94, v94
    v_exp_f32 v95, v95
    v_mfma_f32_32x32x16_bf16 v[64:79], a[16:19], v[168:171], 0
    s_sub_u32 m0, s68, 49152
    v_exp_f32 v48, v48
    v_exp_f32 v49, v49
    v_exp_f32 v50, v50
    v_mfma_f32_32x32x16_bf16 v[64:79], a[20:23], v[172:175], v[64:79]
    s_waitcnt lgkmcnt(0)
    v_exp_f32 v51, v51
    v_exp_f32 v52, v52
    v_exp_f32 v53, v53
    v_smfmac_f32_32x32x32_bf16 v[112:127], a[252:255], v[88:95], v44
    buffer_load_dwordx4 v32, s[16:19], 0 offen offset:0 lds
    v_exp_f32 v54, v54
    v_exp_f32 v55, v55
    v_exp_f32 v56, v56
    v_smfmac_f32_16x16x64_bf16 v[132:135], v[40:43], v[88:95], v44
    buffer_load_dwordx4 v33, s[16:19], 0 offen offset:1024 lds
    v_exp_f32 v57, v57
    v_exp_f32 v58, v58
    v_smfmac_f32_32x32x32_bf16 v[96:111], a[8:11], v[48:55], v44
    buffer_load_dwordx4 v34, s[16:19], 0 offen offset:2048 lds
    v_exp_f32 v59, v59
    v_exp_f32 v60, v60
    v_exp_f32 v61, v61
    v_smfmac_f32_16x16x64_bf16 v[128:131], v[40:43], v[48:55], v44
    buffer_load_dwordx4 v35, s[16:19], 0 offen offset:3072 lds
    v_exp_f32 v62, v62
    v_exp_f32 v63, v63
    v_mfma_f32_32x32x16_bf16 v[80:95], a[32:35], v[168:171], 0
    v_exp_f32 v64, v64
    v_exp_f32 v65, v65
    v_exp_f32 v66, v66
    v_mfma_f32_32x32x16_bf16 v[80:95], a[36:39], v[172:175], v[80:95]
    s_mov_b32 m0, s70
    v_exp_f32 v67, v67
    v_exp_f32 v68, v68
    v_exp_f32 v69, v69
    v_smfmac_f32_32x32x32_bf16 v[96:111], a[12:15], v[56:63], v44
    v_exp_f32 v70, v70
    v_exp_f32 v71, v71
    v_exp_f32 v72, v72
    v_smfmac_f32_16x16x64_bf16 v[128:131], v[40:43], v[56:63], v44
    ds_write_addtid_b32 v112 offset:0
    v_exp_f32 v73, v73
    v_exp_f32 v74, v74
    v_smfmac_f32_32x32x32_bf16 v[96:111], a[24:27], v[64:71], v44
    v_exp_f32 v75, v75
    v_exp_f32 v76, v76
    v_exp_f32 v77, v77
    v_smfmac_f32_16x16x64_bf16 v[128:131], v[40:43], v[64:71], v44
    ds_write_addtid_b32 v113 offset:256
    v_exp_f32 v78, v78
    v_exp_f32 v79, v79
    v_mfma_f32_32x32x16_bf16 v[48:63], a[48:51], v[168:171], 0
    v_exp_f32 v80, v80
    v_exp_f32 v81, v81
    v_exp_f32 v82, v82
    v_mfma_f32_32x32x16_bf16 v[48:63], a[52:55], v[172:175], v[48:63]
    v_exp_f32 v83, v83
    v_exp_f32 v84, v84
    v_exp_f32 v85, v85
    v_smfmac_f32_32x32x32_bf16 v[96:111], a[28:31], v[72:79], v44
    v_exp_f32 v86, v86
    v_exp_f32 v87, v87
    v_exp_f32 v88, v88
    v_smfmac_f32_16x16x64_bf16 v[128:131], v[40:43], v[72:79], v44
    ds_write_addtid_b32 v114 offset:512
    v_exp_f32 v89, v89
    v_exp_f32 v90, v90
    v_smfmac_f32_32x32x32_bf16 v[96:111], a[40:43], v[80:87], v44
    v_exp_f32 v91, v91
    v_exp_f32 v92, v92
    v_exp_f32 v93, v93
    v_smfmac_f32_16x16x64_bf16 v[128:131], v[40:43], v[80:87], v44
    ds_write_addtid_b32 v115 offset:768
    v_exp_f32 v94, v94
    v_exp_f32 v95, v95
    v_mfma_f32_32x32x16_bf16 v[64:79], a[64:67], v[168:171], 0
    v_exp_f32 v48, v48
    v_exp_f32 v49, v49
    v_exp_f32 v50, v50
    v_mfma_f32_32x32x16_bf16 v[64:79], a[68:71], v[172:175], v[64:79]
    v_exp_f32 v51, v51
    v_exp_f32 v52, v52
    v_exp_f32 v53, v53
    v_smfmac_f32_32x32x32_bf16 v[96:111], a[44:47], v[88:95], v44
    v_exp_f32 v54, v54
    v_exp_f32 v55, v55
    v_exp_f32 v56, v56
    v_smfmac_f32_16x16x64_bf16 v[128:131], v[40:43], v[88:95], v44
    ds_write_addtid_b32 v116 offset:1024
    v_exp_f32 v57, v57
    v_exp_f32 v58, v58
    v_smfmac_f32_32x32x32_bf16 v[96:111], a[56:59], v[48:55], v44
    v_exp_f32 v59, v59
    v_exp_f32 v60, v60
    v_exp_f32 v61, v61
    v_smfmac_f32_16x16x64_bf16 v[128:131], v[40:43], v[48:55], v44
    ds_write_addtid_b32 v117 offset:1280
    v_exp_f32 v62, v62
    v_exp_f32 v63, v63
    v_mfma_f32_32x32x16_bf16 v[80:95], a[80:83], v[168:171], 0
    v_exp_f32 v64, v64
    v_exp_f32 v65, v65
    v_exp_f32 v66, v66
    v_mfma_f32_32x32x16_bf16 v[80:95], a[84:87], v[172:175], v[80:95]
    v_exp_f32 v67, v67
    v_exp_f32 v68, v68
    v_exp_f32 v69, v69
    v_smfmac_f32_32x32x32_bf16 v[96:111], a[60:63], v[56:63], v44
    v_exp_f32 v70, v70
    v_exp_f32 v71, v71
    v_exp_f32 v72, v72
    v_smfmac_f32_16x16x64_bf16 v[128:131], v[40:43], v[56:63], v44
    ds_write_addtid_b32 v118 offset:1536
    v_exp_f32 v73, v73
    v_exp_f32 v74, v74
    v_smfmac_f32_32x32x32_bf16 v[96:111], a[72:75], v[64:71], v44
    v_exp_f32 v75, v75
    v_exp_f32 v76, v76
    v_exp_f32 v77, v77
    v_smfmac_f32_16x16x64_bf16 v[128:131], v[40:43], v[64:71], v44
    ds_write_addtid_b32 v119 offset:1792
    v_exp_f32 v78, v78
    v_exp_f32 v79, v79
    v_mfma_f32_32x32x16_bf16 v[48:63], a[96:99], v[168:171], 0
    v_exp_f32 v80, v80
    v_exp_f32 v81, v81
    v_exp_f32 v82, v82
    v_mfma_f32_32x32x16_bf16 v[48:63], a[100:103], v[172:175], v[48:63]
    v_exp_f32 v83, v83
    v_exp_f32 v84, v84
    v_exp_f32 v85, v85
    v_smfmac_f32_32x32x32_bf16 v[96:111], a[76:79], v[72:79], v44
    v_exp_f32 v86, v86
    v_exp_f32 v87, v87
    v_exp_f32 v88, v88
    v_smfmac_f32_16x16x64_bf16 v[128:131], v[40:43], v[72:79], v44
    ds_write_addtid_b32 v120 offset:2048
    v_exp_f32 v89, v89
    v_exp_f32 v90, v90
    v_smfmac_f32_32x32x32_bf16 v[96:111], a[88:91], v[80:87], v44
    v_exp_f32 v91, v91
    v_exp_f32 v92, v92
    v_exp_f32 v93, v93
    v_smfmac_f32_16x16x64_bf16 v[128:131], v[40:43], v[80:87], v44
    ds_write_addtid_b32 v121 offset:2304
    v_exp_f32 v94, v94
    v_exp_f32 v95, v95
    v_mfma_f32_32x32x16_bf16 v[64:79], a[112:115], v[168:171], 0
    v_exp_f32 v48, v48
    v_exp_f32 v49, v49
    v_exp_f32 v50, v50
    v_mfma_f32_32x32x16_bf16 v[64:79], a[116:119], v[172:175], v[64:79]
    v_exp_f32 v51, v51
    v_exp_f32 v52, v52
    v_exp_f32 v53, v53
    v_smfmac_f32_32x32x32_bf16 v[96:111], a[92:95], v[88:95], v44
    v_exp_f32 v54, v54
    v_exp_f32 v55, v55
    v_exp_f32 v56, v56
    v_smfmac_f32_16x16x64_bf16 v[128:131], v[40:43], v[88:95], v44
    ds_write_addtid_b32 v122 offset:2560
    v_exp_f32 v57, v57
    v_exp_f32 v58, v58
    v_smfmac_f32_32x32x32_bf16 v[96:111], a[104:107], v[48:55], v44
    v_exp_f32 v59, v59
    v_exp_f32 v60, v60
    v_exp_f32 v61, v61
    v_smfmac_f32_16x16x64_bf16 v[128:131], v[40:43], v[48:55], v44
    ds_write_addtid_b32 v123 offset:2816
    v_exp_f32 v62, v62
    v_exp_f32 v63, v63
    v_mfma_f32_32x32x16_bf16 v[80:95], a[128:131], v[168:171], 0
    v_exp_f32 v64, v64
    v_exp_f32 v65, v65
    v_exp_f32 v66, v66
    v_mfma_f32_32x32x16_bf16 v[80:95], a[132:135], v[172:175], v[80:95]
    v_exp_f32 v67, v67
    v_exp_f32 v68, v68
    v_exp_f32 v69, v69
    v_smfmac_f32_32x32x32_bf16 v[96:111], a[108:111], v[56:63], v44
    v_exp_f32 v70, v70
    v_exp_f32 v71, v71
    v_exp_f32 v72, v72
    v_smfmac_f32_16x16x64_bf16 v[128:131], v[40:43], v[56:63], v44
    ds_write_addtid_b32 v124 offset:3072
    v_exp_f32 v73, v73
    v_exp_f32 v74, v74
    v_smfmac_f32_32x32x32_bf16 v[96:111], a[120:123], v[64:71], v44
    s_sub_u32 s16, s16, 1507328
    s_subb_u32 s17, s17, 0
    v_exp_f32 v75, v75
    v_exp_f32 v76, v76
    v_exp_f32 v77, v77
    v_smfmac_f32_16x16x64_bf16 v[128:131], v[40:43], v[64:71], v44
    ds_write_addtid_b32 v125 offset:3328
    v_exp_f32 v78, v78
    v_exp_f32 v79, v79
    v_mfma_f32_32x32x16_bf16 v[48:63], a[144:147], v[168:171], 0
    s_sub_u32 m0, s68, 65536
    v_exp_f32 v80, v80
    v_exp_f32 v81, v81
    v_exp_f32 v82, v82
    v_mfma_f32_32x32x16_bf16 v[48:63], a[148:151], v[172:175], v[48:63]
    v_exp_f32 v83, v83
    v_exp_f32 v84, v84
    v_exp_f32 v85, v85
    v_smfmac_f32_32x32x32_bf16 v[96:111], a[124:127], v[72:79], v44
L_pad4:
    s_cbranch_execz L_pad5
    buffer_load_dwordx4 v32, s[16:19], 0 offen offset:0 lds
    v_exp_f32 v86, v86
    v_exp_f32 v87, v87
    v_exp_f32 v88, v88
    v_smfmac_f32_16x16x64_bf16 v[128:131], v[40:43], v[72:79], v44
    buffer_load_dwordx4 v33, s[16:19], 0 offen offset:1024 lds
    v_exp_f32 v89, v89
    v_exp_f32 v90, v90
    v_smfmac_f32_32x32x32_bf16 v[96:111], a[136:139], v[80:87], v44
    buffer_load_dwordx4 v34, s[16:19], 0 offen offset:2048 lds
    v_exp_f32 v91, v91
    v_exp_f32 v92, v92
    v_exp_f32 v93, v93
    v_smfmac_f32_16x16x64_bf16 v[128:131], v[40:43], v[80:87], v44
    buffer_load_dwordx4 v35, s[16:19], 0 offen offset:3072 lds
    v_exp_f32 v94, v94
    v_exp_f32 v95, v95
    v_mfma_f32_32x32x16_bf16 v[64:79], a[160:163], v[168:171], 0
    v_exp_f32 v48, v48
    v_exp_f32 v49, v49
    v_exp_f32 v50, v50
    v_mfma_f32_32x32x16_bf16 v[64:79], a[164:167], v[172:175], v[64:79]
    s_mov_b32 m0, s70
    v_exp_f32 v51, v51
    v_exp_f32 v52, v52
    v_exp_f32 v53, v53
    v_smfmac_f32_32x32x32_bf16 v[96:111], a[140:143], v[88:95], v44
    v_exp_f32 v54, v54
    v_exp_f32 v55, v55
    v_exp_f32 v56, v56
    v_smfmac_f32_16x16x64_bf16 v[128:131], v[40:43], v[88:95], v44
    ds_write_addtid_b32 v126 offset:3584
    v_exp_f32 v57, v57
    v_exp_f32 v58, v58
    v_smfmac_f32_32x32x32_bf16 v[96:111], a[152:155], v[48:55], v44
    v_exp_f32 v59, v59
    v_exp_f32 v60, v60
    v_exp_f32 v61, v61
    v_smfmac_f32_16x16x64_bf16 v[128:131], v[40:43], v[48:55], v44
    ds_write_addtid_b32 v127 offset:3840
    v_exp_f32 v62, v62
    v_exp_f32 v63, v63
    v_mfma_f32_32x32x16_bf16 v[80:95], a[176:179], v[168:171], 0
    v_exp_f32 v64, v64
    v_exp_f32 v65, v65
    v_exp_f32 v66, v66
    v_mfma_f32_32x32x16_bf16 v[80:95], a[180:183], v[172:175], v[80:95]
    v_exp_f32 v67, v67
    v_exp_f32 v68, v68
    v_exp_f32 v69, v69
    v_smfmac_f32_32x32x32_bf16 v[96:111], a[156:159], v[56:63], v44
    v_exp_f32 v70, v70
    v_exp_f32 v71, v71
    v_exp_f32 v72, v72
    v_smfmac_f32_16x16x64_bf16 v[128:131], v[40:43], v[56:63], v44
    ds_write_addtid_b32 v132 offset:4096
    v_exp_f32 v73, v73
    v_exp_f32 v74, v74
    v_smfmac_f32_32x32x32_bf16 v[96:111], a[168:171], v[64:71], v44
    v_exp_f32 v75, v75
    v_exp_f32 v76, v76
    v_exp_f32 v77, v77
    v_smfmac_f32_16x16x64_bf16 v[128:131], v[40:43], v[64:71], v44
    v_exp_f32 v78, v78
    v_exp_f32 v79, v79
    v_mfma_f32_32x32x16_bf16 v[48:63], a[192:195], v[168:171], 0
    v_exp_f32 v80, v80
    v_exp_f32 v81, v81
    v_exp_f32 v82, v82
    v_mfma_f32_32x32x16_bf16 v[48:63], a[196:199], v[172:175], v[48:63]
    s_waitcnt lgkmcnt(0)
    v_exp_f32 v83, v83
    v_exp_f32 v84, v84
    v_exp_f32 v85, v85
    v_smfmac_f32_32x32x32_bf16 v[96:111], a[172:175], v[72:79], v44
    s_barrier
    v_exp_f32 v86, v86
    v_exp_f32 v87, v87
    v_exp_f32 v88, v88
    v_smfmac_f32_16x16x64_bf16 v[128:131], v[40:43], v[72:79], v44
    ds_read2st64_b32 v[112:113], v8 offset0:0 offset1:1
    v_exp_f32 v89, v89
    v_exp_f32 v90, v90
    v_smfmac_f32_32x32x32_bf16 v[96:111], a[184:187], v[80:87], v44
    v_exp_f32 v91, v91
    v_exp_f32 v92, v92
    v_exp_f32 v93, v93
    v_smfmac_f32_16x16x64_bf16 v[128:131], v[40:43], v[80:87], v44
    ds_read2st64_b32 v[114:115], v8 offset0:2 offset1:3
    v_exp_f32 v94, v94
    v_exp_f32 v95, v95
    v_mfma_f32_32x32x16_bf16 v[64:79], a[208:211], v[168:171], 0
    v_exp_f32 v48, v48
    v_exp_f32 v49, v49
    v_exp_f32 v50, v50
    v_mfma_f32_32x32x16_bf16 v[64:79], a[212:215], v[172:175], v[64:79]
    v_exp_f32 v51, v51
    v_exp_f32 v52, v52
    v_exp_f32 v53, v53
    v_smfmac_f32_32x32x32_bf16 v[96:111], a[188:191], v[88:95], v44
    v_exp_f32 v54, v54
    v_exp_f32 v55, v55
    v_exp_f32 v56, v56
    v_smfmac_f32_16x16x64_bf16 v[128:131], v[40:43], v[88:95], v44
    ds_read2st64_b32 v[116:117], v8 offset0:4 offset1:5
    v_exp_f32 v57, v57
    v_exp_f32 v58, v58
    v_smfmac_f32_32x32x32_bf16 v[96:111], a[200:203], v[48:55], v44
    v_exp_f32 v59, v59
    v_exp_f32 v60, v60
    v_exp_f32 v61, v61
    v_smfmac_f32_16x16x64_bf16 v[128:131], v[40:43], v[48:55], v44
    ds_read2st64_b32 v[118:119], v8 offset0:6 offset1:7
    v_exp_f32 v62, v62
    v_exp_f32 v63, v63
    v_mfma_f32_32x32x16_bf16 v[80:95], a[224:227], v[168:171], 0
    v_exp_f32 v64, v64
    v_exp_f32 v65, v65
    v_exp_f32 v66, v66
    v_mfma_f32_32x32x16_bf16 v[80:95], a[228:231], v[172:175], v[80:95]
    v_exp_f32 v67, v67
    v_exp_f32 v68, v68
    v_exp_f32 v69, v69
    v_smfmac_f32_32x32x32_bf16 v[96:111], a[204:207], v[56:63], v44
    v_exp_f32 v70, v70
    v_exp_f32 v71, v71
    v_exp_f32 v72, v72
    v_smfmac_f32_16x16x64_bf16 v[128:131], v[40:43], v[56:63], v44
    ds_read2st64_b32 v[120:121], v8 offset0:8 offset1:9
    v_exp_f32 v73, v73
    v_exp_f32 v74, v74
    v_smfmac_f32_32x32x32_bf16 v[96:111], a[216:219], v[64:71], v44
    v_exp_f32 v75, v75
    v_exp_f32 v76, v76
    v_exp_f32 v77, v77
    v_smfmac_f32_16x16x64_bf16 v[128:131], v[40:43], v[64:71], v44
    ds_read2st64_b32 v[122:123], v8 offset0:10 offset1:11
    v_exp_f32 v78, v78
    v_exp_f32 v79, v79
    v_mfma_f32_32x32x16_bf16 v[48:63], a[240:243], v[168:171], 0
    v_exp_f32 v80, v80
    v_exp_f32 v81, v81
    v_exp_f32 v82, v82
    v_mfma_f32_32x32x16_bf16 v[48:63], a[244:247], v[172:175], v[48:63]
    v_exp_f32 v83, v83
    v_exp_f32 v84, v84
    v_exp_f32 v85, v85
    v_smfmac_f32_32x32x32_bf16 v[96:111], a[220:223], v[72:79], v44
    v_exp_f32 v86, v86
    v_exp_f32 v87, v87
    v_exp_f32 v88, v88
    v_smfmac_f32_16x16x64_bf16 v[128:131], v[40:43], v[72:79], v44
    ds_read2st64_b32 v[124:125], v8 offset0:12 offset1:13
    v_exp_f32 v89, v89
    v_exp_f32 v90, v90
    v_smfmac_f32_32x32x32_bf16 v[96:111], a[232:235], v[80:87], v44
    v_exp_f32 v91, v91
    v_exp_f32 v92, v92
    v_exp_f32 v93, v93
    v_smfmac_f32_16x16x64_bf16 v[128:131], v[40:43], v[80:87], v44
    ds_read2st64_b32 v[126:127], v8 offset0:14 offset1:15
    v_exp_f32 v94, v94
    v_exp_f32 v95, v95
    v_mfma_f32_32x32x16_bf16 v[64:79], a[0:3], v[176:179], 0
    v_exp_f32 v48, v48
    v_exp_f32 v49, v49
    v_exp_f32 v50, v50
    v_mfma_f32_32x32x16_bf16 v[64:79], a[4:7], v[180:183], v[64:79]
    v_exp_f32 v51, v51
    v_exp_f32 v52, v52
    v_exp_f32 v53, v53
    v_smfmac_f32_32x32x32_bf16 v[96:111], a[236:239], v[88:95], v44
    v_exp_f32 v54, v54
    v_exp_f32 v55, v55
    v_exp_f32 v56, v56
    v_smfmac_f32_16x16x64_bf16 v[128:131], v[40:43], v[88:95], v44
    ds_read_b32 v132, v8 offset:4096
    v_exp_f32 v57, v57
    v_exp_f32 v58, v58
    v_smfmac_f32_32x32x32_bf16 v[96:111], a[248:251], v[48:55], v44
    s_add_u32 s16, s16, 524288
    s_addc_u32 s17, s17, 0
    v_exp_f32 v59, v59
    v_exp_f32 v60, v60
    v_exp_f32 v61, v61
    v_smfmac_f32_16x16x64_bf16 v[128:131], v[40:43], v[48:55], v44
    buffer_store_dword v3, v2, s[24:27], 0 offen offset:4092 sc1
    v_exp_f32 v62, v62
    v_exp_f32 v63, v63
    v_mfma_f32_32x32x16_bf16 v[80:95], a[16:19], v[176:179], 0
    s_sub_u32 m0, s68, 81920
    v_exp_f32 v64, v64
    v_exp_f32 v65, v65
    v_exp_f32 v66, v66
    v_mfma_f32_32x32x16_bf16 v[80:95], a[20:23], v[180:183], v[80:95]
    s_waitcnt lgkmcnt(0)
    v_exp_f32 v67, v67
    v_exp_f32 v68, v68
    v_exp_f32 v69, v69
    v_smfmac_f32_32x32x32_bf16 v[96:111], a[252:255], v[56:63], v44
    buffer_load_dwordx4 v32, s[16:19], 0 offen offset:0 lds
    v_exp_f32 v70, v70
    v_exp_f32 v71, v71
    v_exp_f32 v72, v72
    v_smfmac_f32_16x16x64_bf16 v[128:131], v[40:43], v[56:63], v44
    buffer_load_dwordx4 v33, s[16:19], 0 offen offset:1024 lds
    v_exp_f32 v73, v73
    v_exp_f32 v74, v74
    v_smfmac_f32_32x32x32_bf16 v[112:127], a[8:11], v[64:71], v44
    buffer_load_dwordx4 v34, s[16:19], 0 offen offset:2048 lds
    v_exp_f32 v75, v75
    v_exp_f32 v76, v76
    v_exp_f32 v77, v77
    v_smfmac_f32_16x16x64_bf16 v[132:135], v[40:43], v[64:71], v44
    buffer_load_dwordx4 v35, s[16:19], 0 offen offset:3072 lds
    v_exp_f32 v78, v78
    v_exp_f32 v79, v79
    v_mfma_f32_32x32x16_bf16 v[48:63], a[32:35], v[176:179], 0
    v_exp_f32 v80, v80
    v_exp_f32 v81, v81
    v_exp_f32 v82, v82
    v_mfma_f32_32x32x16_bf16 v[48:63], a[36:39], v[180:183], v[48:63]
    s_mov_b32 m0, s70
    v_exp_f32 v83, v83
    v_exp_f32 v84, v84
    v_exp_f32 v85, v85
    v_smfmac_f32_32x32x32_bf16 v[112:127], a[12:15], v[72:79], v44
    v_exp_f32 v86, v86
    v_exp_f32 v87, v87
    v_exp_f32 v88, v88
    v_smfmac_f32_16x16x64_bf16 v[132:135], v[40:43], v[72:79], v44
    ds_write_addtid_b32 v96 offset:17408
    v_exp_f32 v89, v89
    v_exp_f32 v90, v90
    v_smfmac_f32_32x32x32_bf16 v[112:127], a[24:27], v[80:87], v44
    v_exp_f32 v91, v91
    v_exp_f32 v92, v92
    v_exp_f32 v93, v93
    v_smfmac_f32_16x16x64_bf16 v[132:135], v[40:43], v[80:87], v44
    ds_write_addtid_b32 v97 offset:17664
    v_exp_f32 v94, v94
    v_exp_f32 v95, v95
    v_mfma_f32_32x32x16_bf16 v[64:79], a[48:51], v[176:179], 0
    v_exp_f32 v48, v48
    v_exp_f32 v49, v49
    v_exp_f32 v50, v50
    v_mfma_f32_32x32x16_bf16 v[64:79], a[52:55], v[180:183], v[64:79]
    v_exp_f32 v51, v51
    v_exp_f32 v52, v52
    v_exp_f32 v53, v53
    v_smfmac_f32_32x32x32_bf16 v[112:127], a[28:31], v[88:95], v44
    v_exp_f32 v54, v54
    v_exp_f32 v55, v55
    v_exp_f32 v56, v56
    v_smfmac_f32_16x16x64_bf16 v[132:135], v[40:43], v[88:95], v44
    ds_write_addtid_b32 v98 offset:17920
    v_exp_f32 v57, v57
    v_exp_f32 v58, v58
    v_smfmac_f32_32x32x32_bf16 v[112:127], a[40:43], v[48:55], v44
    v_exp_f32 v59, v59
    v_exp_f32 v60, v60
    v_exp_f32 v61, v61
    v_smfmac_f32_16x16x64_bf16 v[132:135], v[40:43], v[48:55], v44
    ds_write_addtid_b32 v99 offset:18176
    v_exp_f32 v62, v62
    v_exp_f32 v63, v63
    v_mfma_f32_32x32x16_bf16 v[80:95], a[64:67], v[176:179], 0
    v_exp_f32 v64, v64
    v_exp_f32 v65, v65
    v_exp_f32 v66, v66
    v_mfma_f32_32x32x16_bf16 v[80:95], a[68:71], v[180:183], v[80:95]
    v_exp_f32 v67, v67
    v_exp_f32 v68, v68
    v_exp_f32 v69, v69
    v_smfmac_f32_32x32x32_bf16 v[112:127], a[44:47], v[56:63], v44
    v_exp_f32 v70, v70
    v_exp_f32 v71, v71
    v_exp_f32 v72, v72
    v_smfmac_f32_16x16x64_bf16 v[132:135], v[40:43], v[56:63], v44
    ds_write_addtid_b32 v100 offset:18432
    v_exp_f32 v73, v73
    v_exp_f32 v74, v74
    v_smfmac_f32_32x32x32_bf16 v[112:127], a[56:59], v[64:71], v44
    v_exp_f32 v75, v75
    v_exp_f32 v76, v76
    v_exp_f32 v77, v77
    v_smfmac_f32_16x16x64_bf16 v[132:135], v[40:43], v[64:71], v44
    ds_write_addtid_b32 v101 offset:18688
    v_exp_f32 v78, v78
    v_exp_f32 v79, v79
    v_mfma_f32_32x32x16_bf16 v[48:63], a[80:83], v[176:179], 0
    v_exp_f32 v80, v80
    v_exp_f32 v81, v81
    v_exp_f32 v82, v82
    v_mfma_f32_32x32x16_bf16 v[48:63], a[84:87], v[180:183], v[48:63]
    v_exp_f32 v83, v83
    v_exp_f32 v84, v84
    v_exp_f32 v85, v85
    v_smfmac_f32_32x32x32_bf16 v[112:127], a[60:63], v[72:79], v44
    v_exp_f32 v86, v86
    v_exp_f32 v87, v87
    v_exp_f32 v88, v88
    v_smfmac_f32_16x16x64_bf16 v[132:135], v[40:43], v[72:79], v44
    ds_write_addtid_b32 v102 offset:18944
    v_exp_f32 v89, v89
    v_exp_f32 v90, v90
    v_smfmac_f32_32x32x32_bf16 v[112:127], a[72:75], v[80:87], v44
    v_exp_f32 v91, v91
    v_exp_f32 v92, v92
    v_exp_f32 v93, v93
    v_smfmac_f32_16x16x64_bf16 v[132:135], v[40:43], v[80:87], v44
    ds_write_addtid_b32 v103 offset:19200
    v_exp_f32 v94, v94
    v_exp_f32 v95, v95
    v_mfma_f32_32x32x16_bf16 v[64:79], a[96:99], v[176:179], 0
    v_exp_f32 v48, v48
    v_exp_f32 v49, v49
    v_exp_f32 v50, v50
    v_mfma_f32_32x32x16_bf16 v[64:79], a[100:103], v[180:183], v[64:79]
    v_exp_f32 v51, v51
    v_exp_f32 v52, v52
    v_exp_f32 v53, v53
    v_smfmac_f32_32x32x32_bf16 v[112:127], a[76:79], v[88:95], v44
    v_exp_f32 v54, v54
    v_exp_f32 v55, v55
    v_exp_f32 v56, v56
    v_smfmac_f32_16x16x64_bf16 v[132:135], v[40:43], v[88:95], v44
    ds_write_addtid_b32 v104 offset:19456
    v_exp_f32 v57, v57
    v_exp_f32 v58, v58
    v_smfmac_f32_32x32x32_bf16 v[112:127], a[88:91], v[48:55], v44
    v_exp_f32 v59, v59
    v_exp_f32 v60, v60
    v_exp_f32 v61, v61
    v_smfmac_f32_16x16x64_bf16 v[132:135], v[40:43], v[48:55], v44
    ds_write_addtid_b32 v105 offset:19712
    v_exp_f32 v62, v62
    v_exp_f32 v63, v63
    v_mfma_f32_32x32x16_bf16 v[80:95], a[112:115], v[176:179], 0
    v_exp_f32 v64, v64
    v_exp_f32 v65, v65
    v_exp_f32 v66, v66
    v_mfma_f32_32x32x16_bf16 v[80:95], a[116:119], v[180:183], v[80:95]
    v_exp_f32 v67, v67
    v_exp_f32 v68, v68
    v_exp_f32 v69, v69
    v_smfmac_f32_32x32x32_bf16 v[112:127], a[92:95], v[56:63], v44
    v_exp_f32 v70, v70
    v_exp_f32 v71, v71
    v_exp_f32 v72, v72
    v_smfmac_f32_16x16x64_bf16 v[132:135], v[40:43], v[56:63], v44
    ds_write_addtid_b32 v106 offset:19968
    v_exp_f32 v73, v73
    v_exp_f32 v74, v74
    v_smfmac_f32_32x32x32_bf16 v[112:127], a[104:107], v[64:71], v44
    v_exp_f32 v75, v75
    v_exp_f32 v76, v76
    v_exp_f32 v77, v77
    v_smfmac_f32_16x16x64_bf16 v[132:135], v[40:43], v[64:71], v44
    ds_write_addtid_b32 v107 offset:20224
    v_exp_f32 v78, v78
    v_exp_f32 v79, v79
    v_mfma_f32_32x32x16_bf16 v[48:63], a[128:131], v[176:179], 0
    v_exp_f32 v80, v80
    v_exp_f32 v81, v81
    v_exp_f32 v82, v82
    v_mfma_f32_32x32x16_bf16 v[48:63], a[132:135], v[180:183], v[48:63]
    v_exp_f32 v83, v83
    v_exp_f32 v84, v84
    v_exp_f32 v85, v85
    v_smfmac_f32_32x32x32_bf16 v[112:127], a[108:111], v[72:79], v44
    v_exp_f32 v86, v86
    v_exp_f32 v87, v87
    v_exp_f32 v88, v88
    v_smfmac_f32_16x16x64_bf16 v[132:135], v[40:43], v[72:79], v44
    ds_write_addtid_b32 v108 offset:20480
    v_exp_f32 v89, v89
    v_exp_f32 v90, v90
    v_smfmac_f32_32x32x32_bf16 v[112:127], a[120:123], v[80:87], v44
    s_add_u32 s16, s16, 524288
    s_addc_u32 s17, s17, 0
    v_exp_f32 v91, v91
    v_exp_f32 v92, v92
    v_exp_f32 v93, v93
    v_smfmac_f32_16x16x64_bf16 v[132:135], v[40:43], v[80:87], v44
    ds_write_addtid_b32 v109 offset:20736
    v_exp_f32 v94, v94
    v_exp_f32 v95, v95
    v_mfma_f32_32x32x16_bf16 v[64:79], a[144:147], v[176:179], 0
    s_sub_u32 m0, s68, 98304
    v_exp_f32 v48, v48
    v_exp_f32 v49, v49
    v_exp_f32 v50, v50
    v_mfma_f32_32x32x16_bf16 v[64:79], a[148:151], v[180:183], v[64:79]
    v_exp_f32 v51, v51
    v_exp_f32 v52, v52
    v_exp_f32 v53, v53
    v_smfmac_f32_32x32x32_bf16 v[112:127], a[124:127], v[88:95], v44
    buffer_load_dwordx4 v32, s[16:19], 0 offen offset:0 lds
    v_exp_f32 v54, v54
    v_exp_f32 v55, v55
    v_exp_f32 v56, v56
    v_smfmac_f32_16x16x64_bf16 v[132:135], v[40:43], v[88:95], v44
    buffer_load_dwordx4 v33, s[16:19], 0 offen offset:1024 lds
    v_exp_f32 v57, v57
    v_exp_f32 v58, v58
    v_smfmac_f32_32x32x32_bf16 v[112:127], a[136:139], v[48:55], v44
    buffer_load_dwordx4 v34, s[16:19], 0 offen offset:2048 lds
    v_exp_f32 v59, v59
    v_exp_f32 v60, v60
    v_exp_f32 v61, v61
    v_smfmac_f32_16x16x64_bf16 v[132:135], v[40:43], v[48:55], v44
    buffer_load_dwordx4 v35, s[16:19], 0 offen offset:3072 lds
    v_exp_f32 v62, v62
    v_exp_f32 v63, v63
    v_mfma_f32_32x32x16_bf16 v[80:95], a[160:163], v[176:179], 0
    v_exp_f32 v64, v64
    v_exp_f32 v65, v65
    v_exp_f32 v66, v66
    v_mfma_f32_32x32x16_bf16 v[80:95], a[164:167], v[180:183], v[80:95]
    s_mov_b32 m0, s70
    v_exp_f32 v67, v67
    v_exp_f32 v68, v68
    v_exp_f32 v69, v69
    v_smfmac_f32_32x32x32_bf16 v[112:127], a[140:143], v[56:63], v44
    v_exp_f32 v70, v70
    v_exp_f32 v71, v71
    v_exp_f32 v72, v72
    v_smfmac_f32_16x16x64_bf16 v[132:135], v[40:43], v[56:63], v44
    ds_write_addtid_b32 v110 offset:20992
    v_exp_f32 v73, v73
    v_exp_f32 v74, v74
    v_smfmac_f32_32x32x32_bf16 v[112:127], a[152:155], v[64:71], v44
    v_exp_f32 v75, v75
    v_exp_f32 v76, v76
    v_exp_f32 v77, v77
    v_smfmac_f32_16x16x64_bf16 v[132:135], v[40:43], v[64:71], v44
    ds_write_addtid_b32 v111 offset:21248
    v_exp_f32 v78, v78
    v_exp_f32 v79, v79
    v_mfma_f32_32x32x16_bf16 v[48:63], a[176:179], v[176:179], 0
    v_exp_f32 v80, v80
    v_exp_f32 v81, v81
    v_exp_f32 v82, v82
    v_mfma_f32_32x32x16_bf16 v[48:63], a[180:183], v[180:183], v[48:63]
    v_exp_f32 v83, v83
    v_exp_f32 v84, v84
    v_exp_f32 v85, v85
    v_smfmac_f32_32x32x32_bf16 v[112:127], a[156:159], v[72:79], v44
    v_exp_f32 v86, v86
    v_exp_f32 v87, v87
    v_exp_f32 v88, v88
    v_smfmac_f32_16x16x64_bf16 v[132:135], v[40:43], v[72:79], v44
    ds_write_addtid_b32 v128 offset:21504
    v_exp_f32 v89, v89
    v_exp_f32 v90, v90
    v_smfmac_f32_32x32x32_bf16 v[112:127], a[168:171], v[80:87], v44
    v_exp_f32 v91, v91
    v_exp_f32 v92, v92
    v_exp_f32 v93, v93
    v_smfmac_f32_16x16x64_bf16 v[132:135], v[40:43], v[80:87], v44
    v_exp_f32 v94, v94
    v_exp_f32 v95, v95
    v_mfma_f32_32x32x16_bf16 v[64:79], a[192:195], v[176:179], 0
    v_exp_f32 v48, v48
    v_exp_f32 v49, v49
    v_exp_f32 v50, v50
    v_mfma_f32_32x32x16_bf16 v[64:79], a[196:199], v[180:183], v[64:79]
    s_waitcnt lgkmcnt(0)
    v_exp_f32 v51, v51
    v_exp_f32 v52, v52
    v_exp_f32 v53, v53
    v_smfmac_f32_32x32x32_bf16 v[112:127], a[172:175], v[88:95], v44
    s_barrier
    v_exp_f32 v54, v54
    v_exp_f32 v55, v55
    v_exp_f32 v56, v56
    v_smfmac_f32_16x16x64_bf16 v[132:135], v[40:43], v[88:95], v44
    ds_read2st64_b32 v[96:97], v8 offset0:68 offset1:69
    v_exp_f32 v57, v57
    v_exp_f32 v58, v58
    v_smfmac_f32_32x32x32_bf16 v[112:127], a[184:187], v[48:55], v44
    v_exp_f32 v59, v59
    v_exp_f32 v60, v60
    v_exp_f32 v61, v61
    v_smfmac_f32_16x16x64_bf16 v[132:135], v[40:43], v[48:55], v44
    ds_read2st64_b32 v[98:99], v8 offset0:70 offset1:71
    v_exp_f32 v62, v62
    v_exp_f32 v63, v63
    v_mfma_f32_32x32x16_bf16 v[80:95], a[208:211], v[176:179], 0
    v_exp_f32 v64, v64
    v_exp_f32 v65, v65
    v_exp_f32 v66, v66
    v_mfma_f32_32x32x16_bf16 v[80:95], a[212:215], v[180:183], v[80:95]
    v_exp_f32 v67, v67
    v_exp_f32 v68, v68
    v_exp_f32 v69, v69
    v_smfmac_f32_32x32x32_bf16 v[112:127], a[188:191], v[56:63], v44
    v_exp_f32 v70, v70
    v_exp_f32 v71, v71
    v_exp_f32 v72, v72
    v_smfmac_f32_16x16x64_bf16 v[132:135], v[40:43], v[56:63], v44
    ds_read2st64_b32 v[100:101], v8 offset0:72 offset1:73
    v_exp_f32 v73, v73
    v_exp_f32 v74, v74
    v_smfmac_f32_32x32x32_bf16 v[112:127], a[200:203], v[64:71], v44
    v_exp_f32 v75, v75
    v_exp_f32 v76, v76
    v_exp_f32 v77, v77
    v_smfmac_f32_16x16x64_bf16 v[132:135], v[40:43], v[64:71], v44
    ds_read2st64_b32 v[102:103], v8 offset0:74 offset1:75
    v_exp_f32 v78, v78
    v_exp_f32 v79, v79
    v_mfma_f32_32x32x16_bf16 v[48:63], a[224:227], v[176:179], 0
    v_exp_f32 v80, v80
    v_exp_f32 v81, v81
    v_exp_f32 v82, v82
    v_mfma_f32_32x32x16_bf16 v[48:63], a[228:231], v[180:183], v[48:63]
    v_exp_f32 v83, v83
    v_exp_f32 v84, v84
    v_exp_f32 v85, v85
    v_smfmac_f32_32x32x32_bf16 v[112:127], a[204:207], v[72:79], v44
    v_exp_f32 v86, v86
    v_exp_f32 v87, v87
    v_exp_f32 v88, v88
    v_smfmac_f32_16x16x64_bf16 v[132:135], v[40:43], v[72:79], v44
    ds_read2st64_b32 v[104:105], v8 offset0:76 offset1:77
    v_exp_f32 v89, v89
    v_exp_f32 v90, v90
    v_smfmac_f32_32x32x32_bf16 v[112:127], a[216:219], v[80:87], v44
    v_exp_f32 v91, v91
    v_exp_f32 v92, v92
    v_exp_f32 v93, v93
    v_smfmac_f32_16x16x64_bf16 v[132:135], v[40:43], v[80:87], v44
    ds_read2st64_b32 v[106:107], v8 offset0:78 offset1:79
    v_exp_f32 v94, v94
    v_exp_f32 v95, v95
    v_mfma_f32_32x32x16_bf16 v[64:79], a[240:243], v[176:179], 0
    v_exp_f32 v48, v48
    v_exp_f32 v49, v49
    v_exp_f32 v50, v50
    v_mfma_f32_32x32x16_bf16 v[64:79], a[244:247], v[180:183], v[64:79]
    v_exp_f32 v51, v51
    v_exp_f32 v52, v52
    v_exp_f32 v53, v53
    v_smfmac_f32_32x32x32_bf16 v[112:127], a[220:223], v[88:95], v44
    v_exp_f32 v54, v54
    v_exp_f32 v55, v55
    v_exp_f32 v56, v56
    v_smfmac_f32_16x16x64_bf16 v[132:135], v[40:43], v[88:95], v44
    ds_read2st64_b32 v[108:109], v8 offset0:80 offset1:81
    v_exp_f32 v57, v57
    v_exp_f32 v58, v58
    v_smfmac_f32_32x32x32_bf16 v[112:127], a[232:235], v[48:55], v44
    v_exp_f32 v59, v59
    v_exp_f32 v60, v60
    v_exp_f32 v61, v61
    v_smfmac_f32_16x16x64_bf16 v[132:135], v[40:43], v[48:55], v44
    ds_read2st64_b32 v[110:111], v8 offset0:82 offset1:83
    v_exp_f32 v62, v62
    v_exp_f32 v63, v63
    v_mfma_f32_32x32x16_bf16 v[80:95], a[0:3], v[184:187], 0
    v_exp_f32 v64, v64
    v_exp_f32 v65, v65
    v_exp_f32 v66, v66
    v_mfma_f32_32x32x16_bf16 v[80:95], a[4:7], v[188:191], v[80:95]
    v_exp_f32 v67, v67
    v_exp_f32 v68, v68
    v_exp_f32 v69, v69
    v_smfmac_f32_32x32x32_bf16 v[112:127], a[236:239], v[56:63], v44
    v_exp_f32 v70, v70
    v_exp_f32 v71, v71
    v_exp_f32 v72, v72
    v_smfmac_f32_16x16x64_bf16 v[132:135], v[40:43], v[56:63], v44
    ds_read_b32 v128, v8 offset:21504
    v_exp_f32 v73, v73
    v_exp_f32 v74, v74
    v_smfmac_f32_32x32x32_bf16 v[112:127], a[248:251], v[64:71], v44
    s_add_u32 s16, s16, 524288
    s_addc_u32 s17, s17, 0
    v_exp_f32 v75, v75
    v_exp_f32 v76, v76
    v_exp_f32 v77, v77
    v_smfmac_f32_16x16x64_bf16 v[132:135], v[40:43], v[64:71], v44
    buffer_load_dword v38, v39, s[24:27], 0 offen offset:4 sc1
    v_exp_f32 v78, v78
    v_exp_f32 v79, v79
    v_mfma_f32_32x32x16_bf16 v[48:63], a[16:19], v[184:187], 0
    v_exp_f32 v80, v80
    v_exp_f32 v81, v81
    v_exp_f32 v82, v82
    v_mfma_f32_32x32x16_bf16 v[48:63], a[20:23], v[188:191], v[48:63]
    s_waitcnt lgkmcnt(0)
    v_exp_f32 v83, v83
    v_exp_f32 v84, v84
    v_exp_f32 v85, v85
    v_smfmac_f32_32x32x32_bf16 v[112:127], a[252:255], v[72:79], v44
    buffer_load_dwordx4 v[200:203], v32, s[16:19], 0 offen offset:0
    v_exp_f32 v86, v86
    v_exp_f32 v87, v87
    v_exp_f32 v88, v88
    v_smfmac_f32_16x16x64_bf16 v[132:135], v[40:43], v[72:79], v44
    buffer_load_dwordx4 v[204:207], v33, s[16:19], 0 offen offset:1024
    v_exp_f32 v89, v89
    v_exp_f32 v90, v90
    v_smfmac_f32_32x32x32_bf16 v[96:111], a[8:11], v[80:87], v44
    buffer_load_dwordx4 v[208:211], v34, s[16:19], 0 offen offset:2048
    v_exp_f32 v91, v91
    v_exp_f32 v92, v92
    v_exp_f32 v93, v93
    v_smfmac_f32_16x16x64_bf16 v[128:131], v[40:43], v[80:87], v44
    buffer_load_dwordx4 v[212:215], v35, s[16:19], 0 offen offset:3072
    v_exp_f32 v94, v94
    v_exp_f32 v95, v95
    v_mfma_f32_32x32x16_bf16 v[64:79], a[32:35], v[184:187], 0
    v_exp_f32 v48, v48
    v_exp_f32 v49, v49
    v_exp_f32 v50, v50
    v_mfma_f32_32x32x16_bf16 v[64:79], a[36:39], v[188:191], v[64:79]
    s_mov_b32 m0, s70
    v_exp_f32 v51, v51
    v_exp_f32 v52, v52
    v_exp_f32 v53, v53
    v_smfmac_f32_32x32x32_bf16 v[96:111], a[12:15], v[88:95], v44
    v_exp_f32 v54, v54
    v_exp_f32 v55, v55
    v_exp_f32 v56, v56
    v_smfmac_f32_16x16x64_bf16 v[128:131], v[40:43], v[88:95], v44
    ds_write_addtid_b32 v112 offset:0
    v_exp_f32 v57, v57
    v_exp_f32 v58, v58
    v_smfmac_f32_32x32x32_bf16 v[96:111], a[24:27], v[48:55], v44
    v_exp_f32 v59, v59
    v_exp_f32 v60, v60
    v_exp_f32 v61, v61
    v_smfmac_f32_16x16x64_bf16 v[128:131], v[40:43], v[48:55], v44
    ds_write_addtid_b32 v113 offset:256
    v_exp_f32 v62, v62
    v_exp_f32 v63, v63
    v_mfma_f32_32x32x16_bf16 v[80:95], a[48:51], v[184:187], 0
    v_exp_f32 v64, v64
    v_exp_f32 v65, v65
    v_exp_f32 v66, v66
    v_mfma_f32_32x32x16_bf16 v[80:95], a[52:55], v[188:191], v[80:95]
    v_exp_f32 v67, v67
    v_exp_f32 v68, v68
    v_exp_f32 v69, v69
    v_smfmac_f32_32x32x32_bf16 v[96:111], a[28:31], v[56:63], v44
    v_exp_f32 v70, v70
    v_exp_f32 v71, v71
    v_exp_f32 v72, v72
    v_smfmac_f32_16x16x64_bf16 v[128:131], v[40:43], v[56:63], v44
    ds_write_addtid_b32 v114 offset:512
    v_exp_f32 v73, v73
    v_exp_f32 v74, v74
    v_smfmac_f32_32x32x32_bf16 v[96:111], a[40:43], v[64:71], v44
    v_exp_f32 v75, v75
    v_exp_f32 v76, v76
    v_exp_f32 v77, v77
    v_smfmac_f32_16x16x64_bf16 v[128:131], v[40:43], v[64:71], v44
    ds_write_addtid_b32 v115 offset:768
    v_exp_f32 v78, v78
    v_exp_f32 v79, v79
    v_mfma_f32_32x32x16_bf16 v[48:63], a[64:67], v[184:187], 0
    v_exp_f32 v80, v80
    v_exp_f32 v81, v81
    v_exp_f32 v82, v82
    v_mfma_f32_32x32x16_bf16 v[48:63], a[68:71], v[188:191], v[48:63]
    v_exp_f32 v83, v83
    v_exp_f32 v84, v84
    v_exp_f32 v85, v85
    v_smfmac_f32_32x32x32_bf16 v[96:111], a[44:47], v[72:79], v44
    v_exp_f32 v86, v86
    v_exp_f32 v87, v87
    v_exp_f32 v88, v88
    v_smfmac_f32_16x16x64_bf16 v[128:131], v[40:43], v[72:79], v44
    ds_write_addtid_b32 v116 offset:1024
    v_exp_f32 v89, v89
    v_exp_f32 v90, v90
    v_smfmac_f32_32x32x32_bf16 v[96:111], a[56:59], v[80:87], v44
    v_exp_f32 v91, v91
    v_exp_f32 v92, v92
    v_exp_f32 v93, v93
    v_smfmac_f32_16x16x64_bf16 v[128:131], v[40:43], v[80:87], v44
    ds_write_addtid_b32 v117 offset:1280
    v_exp_f32 v94, v94
    v_exp_f32 v95, v95
    v_mfma_f32_32x32x16_bf16 v[64:79], a[80:83], v[184:187], 0
    v_exp_f32 v48, v48
    v_exp_f32 v49, v49
    v_exp_f32 v50, v50
    v_mfma_f32_32x32x16_bf16 v[64:79], a[84:87], v[188:191], v[64:79]
    v_exp_f32 v51, v51
    v_exp_f32 v52, v52
    v_exp_f32 v53, v53
    v_smfmac_f32_32x32x32_bf16 v[96:111], a[60:63], v[88:95], v44
    s_lshl_b32 s42, s38, 16
    s_movk_i32 s10, 4096
    v_exp_f32 v54, v54
    v_exp_f32 v55, v55
    v_exp_f32 v56, v56
    v_smfmac_f32_16x16x64_bf16 v[128:131], v[40:43], v[88:95], v44
    ds_write_addtid_b32 v118 offset:1536
    v_exp_f32 v57, v57
    v_exp_f32 v58, v58
    v_smfmac_f32_32x32x32_bf16 v[96:111], a[72:75], v[48:55], v44
    s_add_u32 s8, s32, s42
    s_addc_u32 s9, s33, 0
    v_exp_f32 v59, v59
    v_exp_f32 v60, v60
    v_exp_f32 v61, v61
    v_smfmac_f32_16x16x64_bf16 v[128:131], v[40:43], v[48:55], v44
    ds_write_addtid_b32 v119 offset:1792
    v_exp_f32 v62, v62
    v_exp_f32 v63, v63
    v_mfma_f32_32x32x16_bf16 v[80:95], a[96:99], v[184:187], 0
    v_exp_f32 v64, v64
    v_exp_f32 v65, v65
    v_exp_f32 v66, v66
    v_mfma_f32_32x32x16_bf16 v[80:95], a[100:103], v[188:191], v[80:95]
    v_exp_f32 v67, v67
    v_exp_f32 v68, v68
    v_exp_f32 v69, v69
    v_smfmac_f32_32x32x32_bf16 v[96:111], a[76:79], v[56:63], v44
    v_exp_f32 v70, v70
    v_exp_f32 v71, v71
    v_exp_f32 v72, v72
    v_smfmac_f32_16x16x64_bf16 v[128:131], v[40:43], v[56:63], v44
    ds_write_addtid_b32 v120 offset:2048
    v_exp_f32 v73, v73
    v_exp_f32 v74, v74
    v_smfmac_f32_32x32x32_bf16 v[96:111], a[88:91], v[64:71], v44
    v_exp_f32 v75, v75
    v_exp_f32 v76, v76
    v_exp_f32 v77, v77
    v_smfmac_f32_16x16x64_bf16 v[128:131], v[40:43], v[64:71], v44
    ds_write_addtid_b32 v121 offset:2304
    v_exp_f32 v78, v78
    v_exp_f32 v79, v79
    v_mfma_f32_32x32x16_bf16 v[48:63], a[112:115], v[184:187], 0
    v_exp_f32 v80, v80
    v_exp_f32 v81, v81
    v_exp_f32 v82, v82
    v_mfma_f32_32x32x16_bf16 v[48:63], a[116:119], v[188:191], v[48:63]
    v_exp_f32 v83, v83
    v_exp_f32 v84, v84
    v_exp_f32 v85, v85
    v_smfmac_f32_32x32x32_bf16 v[96:111], a[92:95], v[72:79], v44
    v_exp_f32 v86, v86
    v_exp_f32 v87, v87
    v_exp_f32 v88, v88
    v_smfmac_f32_16x16x64_bf16 v[128:131], v[40:43], v[72:79], v44
    ds_write_addtid_b32 v122 offset:2560
    v_exp_f32 v89, v89
    v_exp_f32 v90, v90
    v_smfmac_f32_32x32x32_bf16 v[96:111], a[104:107], v[80:87], v44
    v_exp_f32 v91, v91
    v_exp_f32 v92, v92
    v_exp_f32 v93, v93
    v_smfmac_f32_16x16x64_bf16 v[128:131], v[40:43], v[80:87], v44
    ds_write_addtid_b32 v123 offset:2816
    v_exp_f32 v94, v94
    v_exp_f32 v95, v95
    v_mfma_f32_32x32x16_bf16 v[64:79], a[128:131], v[184:187], 0
    v_exp_f32 v48, v48
    v_exp_f32 v49, v49
L_pad5:
    s_cbranch_execz L_padback
    v_exp_f32 v50, v50
    v_mfma_f32_32x32x16_bf16 v[64:79], a[132:135], v[188:191], v[64:79]
    v_exp_f32 v51, v51
    v_exp_f32 v52, v52
    v_exp_f32 v53, v53
    v_smfmac_f32_32x32x32_bf16 v[96:111], a[108:111], v[88:95], v44
    v_exp_f32 v54, v54
    v_exp_f32 v55, v55
    v_exp_f32 v56, v56
    v_smfmac_f32_16x16x64_bf16 v[128:131], v[40:43], v[88:95], v44
    ds_write_addtid_b32 v124 offset:3072
    v_exp_f32 v57, v57
    v_exp_f32 v58, v58
    v_smfmac_f32_32x32x32_bf16 v[96:111], a[120:123], v[48:55], v44
    v_exp_f32 v59, v59
    v_exp_f32 v60, v60
    v_exp_f32 v61, v61
    v_smfmac_f32_16x16x64_bf16 v[128:131], v[40:43], v[48:55], v44
    ds_write_addtid_b32 v125 offset:3328
    v_exp_f32 v62, v62
    v_exp_f32 v63, v63
    v_mfma_f32_32x32x16_bf16 v[80:95], a[144:147], v[184:187], 0
    v_exp_f32 v64, v64
    v_exp_f32 v65, v65
    v_exp_f32 v66, v66
    v_mfma_f32_32x32x16_bf16 v[80:95], a[148:151], v[188:191], v[80:95]
    v_exp_f32 v67, v67
    v_exp_f32 v68, v68
    v_exp_f32 v69, v69
    v_smfmac_f32_32x32x32_bf16 v[96:111], a[124:127], v[56:63], v44
    s_waitcnt vmcnt(4)
    v_cmp_ne_u32 vcc, s3, v38
    v_exp_f32 v70, v70
    v_exp_f32 v71, v71
    v_exp_f32 v72, v72
    v_smfmac_f32_16x16x64_bf16 v[128:131], v[40:43], v[56:63], v44
    v_exp_f32 v73, v73
    v_exp_f32 v74, v74
    v_smfmac_f32_32x32x32_bf16 v[96:111], a[136:139], v[64:71], v44
    s_cmp_lg_u64 vcc, 0
    s_cbranch_scc1 L_c2__retry12
L_c2__ok13:
    v_exp_f32 v75, v75
    v_exp_f32 v76, v76
    v_exp_f32 v77, v77
    v_smfmac_f32_16x16x64_bf16 v[128:131], v[40:43], v[64:71], v44
    v_exp_f32 v78, v78
    v_exp_f32 v79, v79
    v_mfma_f32_32x32x16_bf16 v[48:63], a[160:163], v[184:187], 0
    v_exp_f32 v80, v80
    v_exp_f32 v81, v81
    v_exp_f32 v82, v82
    v_mfma_f32_32x32x16_bf16 v[48:63], a[164:167], v[188:191], v[48:63]
    s_mov_b32 m0, s70
    v_exp_f32 v83, v83
    v_exp_f32 v84, v84
    v_exp_f32 v85, v85
    v_smfmac_f32_32x32x32_bf16 v[96:111], a[140:143], v[72:79], v44
    v_exp_f32 v86, v86
    v_exp_f32 v87, v87
    v_exp_f32 v88, v88
    v_smfmac_f32_16x16x64_bf16 v[128:131], v[40:43], v[72:79], v44
    ds_write_addtid_b32 v126 offset:3584
    v_exp_f32 v89, v89
    v_exp_f32 v90, v90
    v_smfmac_f32_32x32x32_bf16 v[96:111], a[152:155], v[80:87], v44
    v_exp_f32 v91, v91
    v_exp_f32 v92, v92
    v_exp_f32 v93, v93
    v_smfmac_f32_16x16x64_bf16 v[128:131], v[40:43], v[80:87], v44
    ds_write_addtid_b32 v127 offset:3840
    v_exp_f32 v94, v94
    v_exp_f32 v95, v95
    v_mfma_f32_32x32x16_bf16 v[64:79], a[176:179], v[184:187], 0
    v_exp_f32 v48, v48
    v_exp_f32 v49, v49
    v_exp_f32 v50, v50
    v_mfma_f32_32x32x16_bf16 v[64:79], a[180:183], v[188:191], v[64:79]
    v_exp_f32 v51, v51
    v_exp_f32 v52, v52
    v_exp_f32 v53, v53
    v_smfmac_f32_32x32x32_bf16 v[96:111], a[156:159], v[88:95], v44
    v_exp_f32 v54, v54
    v_exp_f32 v55, v55
    v_exp_f32 v56, v56
    v_smfmac_f32_16x16x64_bf16 v[128:131], v[40:43], v[88:95], v44
    ds_write_addtid_b32 v132 offset:4096
    v_exp_f32 v57, v57
    v_exp_f32 v58, v58
    v_smfmac_f32_32x32x32_bf16 v[96:111], a[168:171], v[48:55], v44
    v_exp_f32 v59, v59
    v_exp_f32 v60, v60
    v_exp_f32 v61, v61
    v_smfmac_f32_16x16x64_bf16 v[128:131], v[40:43], v[48:55], v44
    v_exp_f32 v62, v62
    v_exp_f32 v63, v63
    v_mfma_f32_32x32x16_bf16 v[80:95], a[192:195], v[184:187], 0
    v_exp_f32 v64, v64
    v_exp_f32 v65, v65
    v_exp_f32 v66, v66
    v_mfma_f32_32x32x16_bf16 v[80:95], a[196:199], v[188:191], v[80:95]
    s_waitcnt lgkmcnt(0)
    v_exp_f32 v67, v67
    v_exp_f32 v68, v68
    v_exp_f32 v69, v69
    v_smfmac_f32_32x32x32_bf16 v[96:111], a[172:175], v[56:63], v44
    s_barrier
    v_exp_f32 v70, v70
    v_exp_f32 v71, v71
    v_exp_f32 v72, v72
    v_smfmac_f32_16x16x64_bf16 v[128:131], v[40:43], v[56:63], v44
    ds_read2st64_b32 v[112:113], v8 offset0:0 offset1:1
    v_exp_f32 v73, v73
    v_exp_f32 v74, v74
    v_smfmac_f32_32x32x32_bf16 v[96:111], a[184:187], v[64:71], v44
    v_exp_f32 v75, v75
    v_exp_f32 v76, v76
    v_exp_f32 v77, v77
    v_smfmac_f32_16x16x64_bf16 v[128:131], v[40:43], v[64:71], v44
    ds_read2st64_b32 v[114:115], v8 offset0:2 offset1:3
    v_exp_f32 v78, v78
    v_exp_f32 v79, v79
    v_mfma_f32_32x32x16_bf16 v[48:63], a[208:211], v[184:187], 0
    v_exp_f32 v80, v80
    v_exp_f32 v81, v81
    v_exp_f32 v82, v82
    v_mfma_f32_32x32x16_bf16 v[48:63], a[212:215], v[188:191], v[48:63]
    v_exp_f32 v83, v83
    v_exp_f32 v84, v84
    v_exp_f32 v85, v85
    v_smfmac_f32_32x32x32_bf16 v[96:111], a[188:191], v[72:79], v44
    v_exp_f32 v86, v86
    v_exp_f32 v87, v87
    v_exp_f32 v88, v88
    v_smfmac_f32_16x16x64_bf16 v[128:131], v[40:43], v[72:79], v44
    ds_read2st64_b32 v[116:117], v8 offset0:4 offset1:5
    v_exp_f32 v89, v89
    v_exp_f32 v90, v90
    v_smfmac_f32_32x32x32_bf16 v[96:111], a[200:203], v[80:87], v44
    v_exp_f32 v91, v91
    v_exp_f32 v92, v92
    v_exp_f32 v93, v93
    v_smfmac_f32_16x16x64_bf16 v[128:131], v[40:43], v[80:87], v44
    ds_read2st64_b32 v[118:119], v8 offset0:6 offset1:7
    v_exp_f32 v94, v94
    v_exp_f32 v95, v95
    v_mfma_f32_32x32x16_bf16 v[64:79], a[224:227], v[184:187], 0
    v_exp_f32 v48, v48
    v_exp_f32 v49, v49
    v_exp_f32 v50, v50
    v_mfma_f32_32x32x16_bf16 v[64:79], a[228:231], v[188:191], v[64:79]
    v_exp_f32 v51, v51
    v_exp_f32 v52, v52
    v_exp_f32 v53, v53
    v_smfmac_f32_32x32x32_bf16 v[96:111], a[204:207], v[88:95], v44
    v_exp_f32 v54, v54
    v_exp_f32 v55, v55
    v_exp_f32 v56, v56
    v_smfmac_f32_16x16x64_bf16 v[128:131], v[40:43], v[88:95], v44
    ds_read2st64_b32 v[120:121], v8 offset0:8 offset1:9
    v_exp_f32 v57, v57
    v_exp_f32 v58, v58
    v_smfmac_f32_32x32x32_bf16 v[96:111], a[216:219], v[48:55], v44
    v_exp_f32 v59, v59
    v_exp_f32 v60, v60
    v_exp_f32 v61, v61
    v_smfmac_f32_16x16x64_bf16 v[128:131], v[40:43], v[48:55], v44
    ds_read2st64_b32 v[122:123], v8 offset0:10 offset1:11
    v_exp_f32 v62, v62
    v_exp_f32 v63, v63
    v_mfma_f32_32x32x16_bf16 v[80:95], a[240:243], v[184:187], 0
    v_exp_f32 v64, v64
    v_exp_f32 v65, v65
    v_exp_f32 v66, v66
    v_mfma_f32_32x32x16_bf16 v[80:95], a[244:247], v[188:191], v[80:95]
    v_exp_f32 v67, v67
    v_exp_f32 v68, v68
    v_exp_f32 v69, v69
    v_smfmac_f32_32x32x32_bf16 v[96:111], a[220:223], v[56:63], v44
    v_exp_f32 v70, v70
    v_exp_f32 v71, v71
    v_exp_f32 v72, v72
    v_smfmac_f32_16x16x64_bf16 v[128:131], v[40:43], v[56:63], v44
    ds_read2st64_b32 v[124:125], v8 offset0:12 offset1:13
    v_exp_f32 v73, v73
    v_exp_f32 v74, v74
    v_smfmac_f32_32x32x32_bf16 v[96:111], a[232:235], v[64:71], v44
    v_exp_f32 v75, v75
    v_exp_f32 v76, v76
    v_exp_f32 v77, v77
    v_smfmac_f32_16x16x64_bf16 v[128:131], v[40:43], v[64:71], v44
    ds_read2st64_b32 v[126:127], v8 offset0:14 offset1:15
    v_exp_f32 v78, v78
    v_exp_f32 v79, v79
    v_mfma_f32_32x32x16_bf16 v[48:63], a[0:3], v[192:195], 0
    v_exp_f32 v80, v80
    v_exp_f32 v81, v81
    v_exp_f32 v82, v82
    v_mfma_f32_32x32x16_bf16 v[48:63], a[4:7], v[196:199], v[48:63]
    v_exp_f32 v83, v83
    v_exp_f32 v84, v84
    v_exp_f32 v85, v85
    v_smfmac_f32_32x32x32_bf16 v[96:111], a[236:239], v[72:79], v44
    v_exp_f32 v86, v86
    v_exp_f32 v87, v87
    v_exp_f32 v88, v88
    v_smfmac_f32_16x16x64_bf16 v[128:131], v[40:43], v[72:79], v44
    ds_read_b32 v132, v8 offset:4096
    v_exp_f32 v89, v89
    v_exp_f32 v90, v90
    v_smfmac_f32_32x32x32_bf16 v[96:111], a[248:251], v[80:87], v44
    s_sub_u32 m0, s68, 114688
    v_exp_f32 v91, v91
    v_exp_f32 v92, v92
    v_exp_f32 v93, v93
    v_smfmac_f32_16x16x64_bf16 v[128:131], v[40:43], v[80:87], v44
    buffer_load_dwordx4 v32, s[16:19], 0 offen offset:0 lds
    v_exp_f32 v94, v94
    v_exp_f32 v95, v95
    v_mfma_f32_32x32x16_bf16 v[64:79], a[16:19], v[192:195], 0
    v_exp_f32 v48, v48
    v_exp_f32 v49, v49
    v_exp_f32 v50, v50
    v_mfma_f32_32x32x16_bf16 v[64:79], a[20:23], v[196:199], v[64:79]
    s_waitcnt lgkmcnt(0)
    v_exp_f32 v51, v51
    v_exp_f32 v52, v52
    v_exp_f32 v53, v53
    v_smfmac_f32_32x32x32_bf16 v[96:111], a[252:255], v[88:95], v44
    buffer_load_dwordx4 v33, s[16:19], 0 offen offset:1024 lds
    v_exp_f32 v54, v54
    v_exp_f32 v55, v55
    v_exp_f32 v56, v56
    v_smfmac_f32_16x16x64_bf16 v[128:131], v[40:43], v[88:95], v44
    buffer_load_dwordx4 v34, s[16:19], 0 offen offset:2048 lds
    v_exp_f32 v57, v57
    v_exp_f32 v58, v58
    v_smfmac_f32_32x32x32_bf16 v[112:127], a[8:11], v[48:55], v44
    v_exp_f32 v59, v59
    v_exp_f32 v60, v60
    v_exp_f32 v61, v61
    v_smfmac_f32_16x16x64_bf16 v[132:135], v[40:43], v[48:55], v44
    buffer_load_dwordx4 v35, s[16:19], 0 offen offset:3072 lds
    v_exp_f32 v62, v62
    v_exp_f32 v63, v63
    v_mfma_f32_32x32x16_bf16 v[80:95], a[32:35], v[192:195], 0
    v_subrev_u32 v1, 0x3f800000, v128
    v_cmp_lt_u32 vcc, 0x28000000, v1
    v_rcp_f32 v46, v128
    v_exp_f32 v64, v64
    v_exp_f32 v65, v65
    v_exp_f32 v66, v66
    v_mfma_f32_32x32x16_bf16 v[80:95], a[36:39], v[196:199], v[80:95]
    s_cmp_lg_u64 vcc, 0
    s_cbranch_scc1 L_fb15
L_fbret16:
    v_mul_f32 v96, v46, v96
    v_mul_f32 v97, v46, v97
    v_mul_f32 v98, v46, v98
    v_mul_f32 v99, v46, v99
    v_mul_f32 v100, v46, v100
    v_mul_f32 v101, v46, v101
    v_mul_f32 v102, v46, v102
    v_mul_f32 v103, v46, v103
    v_exp_f32 v67, v67
    v_exp_f32 v68, v68
    v_exp_f32 v69, v69
    v_smfmac_f32_32x32x32_bf16 v[112:127], a[12:15], v[56:63], v44
    v_cvt_pk_bf16_f32 v24, v96, v97
    v_cvt_pk_bf16_f32 v25, v98, v99
    v_cvt_pk_bf16_f32 v26, v100, v101
    v_cvt_pk_bf16_f32 v27, v102, v103
    v_exp_f32 v70, v70
    v_exp_f32 v71, v71
    v_exp_f32 v72, v72
    v_smfmac_f32_16x16x64_bf16 v[132:135], v[40:43], v[56:63], v44
    buffer_store_dwordx4 v[24:27], v9, s[32:35], 0 offen offset:0 sc1
    v_exp_f32 v73, v73
    v_exp_f32 v74, v74
    v_smfmac_f32_32x32x32_bf16 v[112:127], a[24:27], v[64:71], v44
    v_mul_f32 v104, v46, v104
    v_mul_f32 v105, v46, v105
    v_mul_f32 v106, v46, v106
    v_mul_f32 v107, v46, v107
    v_mul_f32 v108, v46, v108
    v_mul_f32 v109, v46, v109
    v_mul_f32 v110, v46, v110
    v_mul_f32 v111, v46, v111
    v_cvt_pk_bf16_f32 v28, v104, v105
    v_cvt_pk_bf16_f32 v29, v106, v107
    v_cvt_pk_bf16_f32 v30, v108, v109
    v_cvt_pk_bf16_f32 v31, v110, v111
    v_exp_f32 v75, v75
    v_exp_f32 v76, v76
    v_exp_f32 v77, v77
    v_smfmac_f32_16x16x64_bf16 v[132:135], v[40:43], v[64:71], v44
    buffer_store_dwordx4 v[28:31], v9, s[32:35], 0 offen offset:512 sc1
    v_exp_f32 v78, v78
    v_exp_f32 v79, v79
    v_mfma_f32_32x32x16_bf16 v[48:63], a[48:51], v[192:195], 0
    v_exp_f32 v80, v80
    v_exp_f32 v81, v81
    v_exp_f32 v82, v82
    v_mfma_f32_32x32x16_bf16 v[48:63], a[52:55], v[196:199], v[48:63]
    v_exp_f32 v83, v83
    v_exp_f32 v84, v84
    v_exp_f32 v85, v85
    v_smfmac_f32_32x32x32_bf16 v[112:127], a[28:31], v[72:79], v44
    v_exp_f32 v86, v86
    v_exp_f32 v87, v87
    v_exp_f32 v88, v88
    v_smfmac_f32_16x16x64_bf16 v[132:135], v[40:43], v[72:79], v44
    v_exp_f32 v89, v89
    v_exp_f32 v90, v90
    v_smfmac_f32_32x32x32_bf16 v[112:127], a[40:43], v[80:87], v44
    v_exp_f32 v91, v91
    v_exp_f32 v92, v92
    v_exp_f32 v93, v93
    v_smfmac_f32_16x16x64_bf16 v[132:135], v[40:43], v[80:87], v44
    v_exp_f32 v94, v94
    v_exp_f32 v95, v95
    v_mfma_f32_32x32x16_bf16 v[64:79], a[64:67], v[192:195], 0
    v_exp_f32 v48, v48
    v_exp_f32 v49, v49
    v_exp_f32 v50, v50
    v_mfma_f32_32x32x16_bf16 v[64:79], a[68:71], v[196:199], v[64:79]
    v_exp_f32 v51, v51
    v_exp_f32 v52, v52
    v_exp_f32 v53, v53
    v_smfmac_f32_32x32x32_bf16 v[112:127], a[44:47], v[88:95], v44
    v_exp_f32 v54, v54
    v_exp_f32 v55, v55
    v_exp_f32 v56, v56
    v_smfmac_f32_16x16x64_bf16 v[132:135], v[40:43], v[88:95], v44
    v_exp_f32 v57, v57
    v_exp_f32 v58, v58
    v_smfmac_f32_32x32x32_bf16 v[112:127], a[56:59], v[48:55], v44
    v_exp_f32 v59, v59
    v_exp_f32 v60, v60
    v_exp_f32 v61, v61
    v_smfmac_f32_16x16x64_bf16 v[132:135], v[40:43], v[48:55], v44
    v_exp_f32 v62, v62
    v_exp_f32 v63, v63
    v_mfma_f32_32x32x16_bf16 v[80:95], a[80:83], v[192:195], 0
    v_exp_f32 v64, v64
    v_exp_f32 v65, v65
    v_exp_f32 v66, v66
    v_mfma_f32_32x32x16_bf16 v[80:95], a[84:87], v[196:199], v[80:95]
    v_exp_f32 v67, v67
    v_exp_f32 v68, v68
    v_exp_f32 v69, v69
    v_smfmac_f32_32x32x32_bf16 v[112:127], a[60:63], v[56:63], v44
    v_exp_f32 v70, v70
    v_exp_f32 v71, v71
    v_exp_f32 v72, v72
    v_smfmac_f32_16x16x64_bf16 v[132:135], v[40:43], v[56:63], v44
    v_exp_f32 v73, v73
    v_exp_f32 v74, v74
    v_smfmac_f32_32x32x32_bf16 v[112:127], a[72:75], v[64:71], v44
    v_exp_f32 v75, v75
    v_exp_f32 v76, v76
    v_exp_f32 v77, v77
    v_smfmac_f32_16x16x64_bf16 v[132:135], v[40:43], v[64:71], v44
    v_exp_f32 v78, v78
    v_exp_f32 v79, v79
    v_mfma_f32_32x32x16_bf16 v[48:63], a[96:99], v[192:195], 0
    v_exp_f32 v80, v80
    v_exp_f32 v81, v81
    v_exp_f32 v82, v82
    v_mfma_f32_32x32x16_bf16 v[48:63], a[100:103], v[196:199], v[48:63]
    v_exp_f32 v83, v83
    v_exp_f32 v84, v84
    v_exp_f32 v85, v85
    v_smfmac_f32_32x32x32_bf16 v[112:127], a[76:79], v[72:79], v44
    v_exp_f32 v86, v86
    v_exp_f32 v87, v87
    v_exp_f32 v88, v88
    v_smfmac_f32_16x16x64_bf16 v[132:135], v[40:43], v[72:79], v44
    v_exp_f32 v89, v89
    v_exp_f32 v90, v90
    v_smfmac_f32_32x32x32_bf16 v[112:127], a[88:91], v[80:87], v44
    v_exp_f32 v91, v91
    v_exp_f32 v92, v92
    v_exp_f32 v93, v93
    v_smfmac_f32_16x16x64_bf16 v[132:135], v[40:43], v[80:87], v44
    v_exp_f32 v94, v94
    v_exp_f32 v95, v95
    v_mfma_f32_32x32x16_bf16 v[64:79], a[112:115], v[192:195], 0
    v_exp_f32 v48, v48
    v_exp_f32 v49, v49
    v_exp_f32 v50, v50
    v_mfma_f32_32x32x16_bf16 v[64:79], a[116:119], v[196:199], v[64:79]
    s_waitcnt vmcnt(2)
    v_exp_f32 v51, v51
    v_exp_f32 v52, v52
    v_exp_f32 v53, v53
    v_smfmac_f32_32x32x32_bf16 v[112:127], a[92:95], v[88:95], v44
    s_barrier
    v_exp_f32 v54, v54
    v_exp_f32 v55, v55
    v_exp_f32 v56, v56
    v_smfmac_f32_16x16x64_bf16 v[132:135], v[40:43], v[88:95], v44
    v_exp_f32 v57, v57
    v_exp_f32 v58, v58
    v_smfmac_f32_32x32x32_bf16 v[112:127], a[104:107], v[48:55], v44
    v_exp_f32 v59, v59
    v_exp_f32 v60, v60
    v_exp_f32 v61, v61
    v_smfmac_f32_16x16x64_bf16 v[132:135], v[40:43], v[48:55], v44
    v_exp_f32 v62, v62
    v_exp_f32 v63, v63
    v_mfma_f32_32x32x16_bf16 v[80:95], a[128:131], v[192:195], 0
    v_exp_f32 v64, v64
    v_exp_f32 v65, v65
    v_exp_f32 v66, v66
    v_mfma_f32_32x32x16_bf16 v[80:95], a[132:135], v[196:199], v[80:95]
    v_exp_f32 v67, v67
    v_exp_f32 v68, v68
    v_exp_f32 v69, v69
    v_smfmac_f32_32x32x32_bf16 v[112:127], a[108:111], v[56:63], v44
    v_exp_f32 v70, v70
    v_exp_f32 v71, v71
    v_exp_f32 v72, v72
    v_smfmac_f32_16x16x64_bf16 v[132:135], v[40:43], v[56:63], v44
    buffer_load_dword v38, v10, s[32:35], 0 offen sc1
    v_exp_f32 v73, v73
    v_exp_f32 v74, v74
    v_smfmac_f32_32x32x32_bf16 v[112:127], a[120:123], v[64:71], v44
    v_exp_f32 v75, v75
    v_exp_f32 v76, v76
    v_exp_f32 v77, v77
    v_smfmac_f32_16x16x64_bf16 v[132:135], v[40:43], v[64:71], v44
    v_exp_f32 v78, v78
    v_exp_f32 v79, v79
    v_mfma_f32_32x32x16_bf16 v[48:63], a[144:147], v[192:195], 0
    v_exp_f32 v80, v80
    v_exp_f32 v81, v81
    v_exp_f32 v82, v82
    v_mfma_f32_32x32x16_bf16 v[48:63], a[148:151], v[196:199], v[48:63]
    v_exp_f32 v83, v83
    v_exp_f32 v84, v84
    v_exp_f32 v85, v85
    v_smfmac_f32_32x32x32_bf16 v[112:127], a[124:127], v[72:79], v44
    v_exp_f32 v86, v86
    v_exp_f32 v87, v87
    v_exp_f32 v88, v88
    v_smfmac_f32_16x16x64_bf16 v[132:135], v[40:43], v[72:79], v44
    v_exp_f32 v89, v89
    v_exp_f32 v90, v90
    v_smfmac_f32_32x32x32_bf16 v[112:127], a[136:139], v[80:87], v44
    v_exp_f32 v91, v91
    v_exp_f32 v92, v92
    v_exp_f32 v93, v93
    v_smfmac_f32_16x16x64_bf16 v[132:135], v[40:43], v[80:87], v44
    v_exp_f32 v94, v94
    v_exp_f32 v95, v95
    v_mfma_f32_32x32x16_bf16 v[64:79], a[160:163], v[192:195], 0
    v_exp_f32 v48, v48
    v_exp_f32 v49, v49
    v_exp_f32 v50, v50
    v_mfma_f32_32x32x16_bf16 v[64:79], a[164:167], v[196:199], v[64:79]
    v_exp_f32 v51, v51
    v_exp_f32 v52, v52
    v_exp_f32 v53, v53
    v_smfmac_f32_32x32x32_bf16 v[112:127], a[140:143], v[88:95], v44
    v_exp_f32 v54, v54
    v_exp_f32 v55, v55
    v_exp_f32 v56, v56
    v_smfmac_f32_16x16x64_bf16 v[132:135], v[40:43], v[88:95], v44
    v_exp_f32 v57, v57
    v_exp_f32 v58, v58
    v_smfmac_f32_32x32x32_bf16 v[112:127], a[152:155], v[48:55], v44
    v_exp_f32 v59, v59
    v_exp_f32 v60, v60
    v_exp_f32 v61, v61
    v_smfmac_f32_16x16x64_bf16 v[132:135], v[40:43], v[48:55], v44
    v_exp_f32 v62, v62
    v_exp_f32 v63, v63
    v_mfma_f32_32x32x16_bf16 v[80:95], a[176:179], v[192:195], 0
    v_exp_f32 v64, v64
    v_exp_f32 v65, v65
    v_exp_f32 v66, v66
    v_mfma_f32_32x32x16_bf16 v[80:95], a[180:183], v[196:199], v[80:95]
    s_waitcnt vmcnt(0)
    v_cmp_eq_u32 vcc, -1, v38
    v_exp_f32 v67, v67
    v_exp_f32 v68, v68
    v_exp_f32 v69, v69
    v_smfmac_f32_32x32x32_bf16 v[112:127], a[156:159], v[56:63], v44
    s_cmp_lg_u64 vcc, 0
    s_cbranch_scc1 L_gate0__retry19
L_gate0__ok20:
    v_exp_f32 v70, v70
    v_exp_f32 v71, v71
    v_exp_f32 v72, v72
    v_smfmac_f32_16x16x64_bf16 v[132:135], v[40:43], v[56:63], v44
    buffer_load_dwordx4 v[96:99], v37, s[8:11], 0 offen offset:0 sc1
    v_exp_f32 v73, v73
    v_exp_f32 v74, v74
    v_smfmac_f32_32x32x32_bf16 v[112:127], a[168:171], v[64:71], v44
    v_exp_f32 v75, v75
    v_exp_f32 v76, v76
    v_exp_f32 v77, v77
    v_smfmac_f32_16x16x64_bf16 v[132:135], v[40:43], v[64:71], v44
    buffer_load_dwordx4 v[100:103], v37, s[8:11], 0 offen offset:1024 sc1
    v_exp_f32 v78, v78
    v_exp_f32 v79, v79
    v_mfma_f32_32x32x16_bf16 v[48:63], a[192:195], v[192:195], 0
    v_exp_f32 v80, v80
    v_exp_f32 v81, v81
    v_exp_f32 v82, v82
    v_mfma_f32_32x32x16_bf16 v[48:63], a[196:199], v[196:199], v[48:63]
    v_exp_f32 v83, v83
    v_exp_f32 v84, v84
    v_exp_f32 v85, v85
    v_smfmac_f32_32x32x32_bf16 v[112:127], a[172:175], v[72:79], v44
    v_exp_f32 v86, v86
    v_exp_f32 v87, v87
    v_exp_f32 v88, v88
    v_smfmac_f32_16x16x64_bf16 v[132:135], v[40:43], v[72:79], v44
    buffer_load_dwordx4 v[104:107], v37, s[8:11], 0 offen offset:2048 sc1
    v_exp_f32 v89, v89
    v_exp_f32 v90, v90
    v_smfmac_f32_32x32x32_bf16 v[112:127], a[184:187], v[80:87], v44
    v_exp_f32 v91, v91
    v_exp_f32 v92, v92
    v_exp_f32 v93, v93
    v_smfmac_f32_16x16x64_bf16 v[132:135], v[40:43], v[80:87], v44
    buffer_load_dwordx4 v[108:111], v37, s[8:11], 0 offen offset:3072 sc1
    v_exp_f32 v94, v94
    v_exp_f32 v95, v95
    v_mfma_f32_32x32x16_bf16 v[64:79], a[208:211], v[192:195], 0
    v_exp_f32 v48, v48
    v_exp_f32 v49, v49
    v_exp_f32 v50, v50
    v_mfma_f32_32x32x16_bf16 v[64:79], a[212:215], v[196:199], v[64:79]
    v_exp_f32 v51, v51
    v_exp_f32 v52, v52
    v_exp_f32 v53, v53
    v_smfmac_f32_32x32x32_bf16 v[112:127], a[188:191], v[88:95], v44
    s_add_u32 s8, s8, 4096
    s_addc_u32 s9, s9, 0
    v_exp_f32 v54, v54
    v_exp_f32 v55, v55
    v_exp_f32 v56, v56
    v_smfmac_f32_16x16x64_bf16 v[132:135], v[40:43], v[88:95], v44
    buffer_load_dwordx4 v[136:139], v37, s[8:11], 0 offen offset:0 sc1
    v_exp_f32 v57, v57
    v_exp_f32 v58, v58
    v_smfmac_f32_32x32x32_bf16 v[112:127], a[200:203], v[48:55], v44
    v_exp_f32 v59, v59
    v_exp_f32 v60, v60
    v_exp_f32 v61, v61
    v_smfmac_f32_16x16x64_bf16 v[132:135], v[40:43], v[48:55], v44
    buffer_load_dwordx4 v[140:143], v37, s[8:11], 0 offen offset:1024 sc1
    v_exp_f32 v62, v62
    v_exp_f32 v63, v63
    v_mfma_f32_32x32x16_bf16 v[80:95], a[224:227], v[192:195], 0
    v_exp_f32 v64, v64
    v_exp_f32 v65, v65
    v_exp_f32 v66, v66
    v_mfma_f32_32x32x16_bf16 v[80:95], a[228:231], v[196:199], v[80:95]
    v_exp_f32 v67, v67
    v_exp_f32 v68, v68
    v_exp_f32 v69, v69
    v_smfmac_f32_32x32x32_bf16 v[112:127], a[204:207], v[56:63], v44
    v_exp_f32 v70, v70
    v_exp_f32 v71, v71
    v_exp_f32 v72, v72
    v_smfmac_f32_16x16x64_bf16 v[132:135], v[40:43], v[56:63], v44
    buffer_load_dwordx4 v[144:147], v37, s[8:11], 0 offen offset:2048 sc1
    v_exp_f32 v73, v73
    v_exp_f32 v74, v74
    v_smfmac_f32_32x32x32_bf16 v[112:127], a[216:219], v[64:71], v44
    v_exp_f32 v75, v75
    v_exp_f32 v76, v76
    v_exp_f32 v77, v77
    v_smfmac_f32_16x16x64_bf16 v[132:135], v[40:43], v[64:71], v44
    buffer_load_dwordx4 v[148:151], v37, s[8:11], 0 offen offset:3072 sc1
    v_exp_f32 v78, v78
    v_exp_f32 v79, v79
    v_mfma_f32_32x32x16_bf16 v[48:63], a[240:243], v[192:195], 0
    v_exp_f32 v80, v80
    v_exp_f32 v81, v81
    v_exp_f32 v82, v82
    v_mfma_f32_32x32x16_bf16 v[48:63], a[244:247], v[196:199], v[48:63]
    v_exp_f32 v83, v83
    v_exp_f32 v84, v84
    v_exp_f32 v85, v85
    v_smfmac_f32_32x32x32_bf16 v[112:127], a[220:223], v[72:79], v44
    s_add_u32 s8, s8, 4096
    s_addc_u32 s9, s9, 0
    v_exp_f32 v86, v86
    v_exp_f32 v87, v87
    v_exp_f32 v88, v88
    v_smfmac_f32_16x16x64_bf16 v[132:135], v[40:43], v[72:79], v44
    buffer_load_dwordx4 v[152:155], v37, s[8:11], 0 offen offset:0 sc1
    v_exp_f32 v89, v89
    v_exp_f32 v90, v90
    v_smfmac_f32_32x32x32_bf16 v[112:127], a[232:235], v[80:87], v44
    v_exp_f32 v91, v91
    v_exp_f32 v92, v92
    v_exp_f32 v93, v93
    v_smfmac_f32_16x16x64_bf16 v[132:135], v[40:43], v[80:87], v44
    buffer_load_dwordx4 v[156:159], v37, s[8:11], 0 offen offset:1024 sc1
    v_exp_f32 v94, v94
    v_exp_f32 v95, v95
    v_exp_f32 v48, v48
    v_exp_f32 v49, v49
    v_exp_f32 v50, v50
    v_exp_f32 v51, v51
    v_exp_f32 v52, v52
    v_exp_f32 v53, v53
    v_smfmac_f32_32x32x32_bf16 v[112:127], a[236:239], v[88:95], v44
    v_exp_f32 v54, v54
    v_exp_f32 v55, v55
    v_exp_f32 v56, v56
    v_smfmac_f32_16x16x64_bf16 v[132:135], v[40:43], v[88:95], v44
    buffer_load_dwordx4 v[160:163], v37, s[8:11], 0 offen offset:2048 sc1
    v_exp_f32 v57, v57
    v_exp_f32 v58, v58
    v_smfmac_f32_32x32x32_bf16 v[112:127], a[248:251], v[48:55], v44
    v_exp_f32 v59, v59
    v_exp_f32 v60, v60
    v_exp_f32 v61, v61
    v_smfmac_f32_16x16x64_bf16 v[132:135], v[40:43], v[48:55], v44
    buffer_load_dwordx4 v[164:167], v37, s[8:11], 0 offen offset:3072 sc1
    v_exp_f32 v62, v62
    v_exp_f32 v63, v63
    ds_read_b64_tr_b16 a[128:129], v16 offset:61440
    ds_read_b64_tr_b16 a[130:131], v16 offset:62464
    v_smfmac_f32_16x16x64_bf16 v[132:135], v[40:43], v[56:63], v44
    v_smfmac_f32_32x32x32_bf16 v[112:127], a[252:255], v[56:63], v44
    ds_read_b64_tr_b16 a[132:133], v17 offset:61440
    ds_read_b64_tr_b16 a[134:135], v17 offset:62464
    ds_read_b64_tr_b16 a[136:137], v18 offset:61440
    ds_read_b64_tr_b16 a[138:139], v18 offset:62464
    ds_read_b64_tr_b16 a[140:141], v19 offset:61440
    ds_read_b64_tr_b16 a[142:143], v19 offset:62464
    ds_read_b64_tr_b16 a[144:145], v16 offset:57344
    v_subrev_u32 v1, 0x3f800000, v132
    v_cmp_lt_u32 vcc, 0x28000000, v1
    v_rcp_f32 v46, v132
    s_cmp_lg_u64 vcc, 0
    s_cbranch_scc1 L_fb22
L_fbret23:
    v_pk_mul_f32 v[112:113], v[112:113], v[46:47] op_sel_hi:[1,0]
    v_pk_mul_f32 v[114:115], v[114:115], v[46:47] op_sel_hi:[1,0]
    v_pk_mul_f32 v[116:117], v[116:117], v[46:47] op_sel_hi:[1,0]
    v_pk_mul_f32 v[118:119], v[118:119], v[46:47] op_sel_hi:[1,0]
    v_cvt_pk_bf16_f32 v24, v112, v113
    v_cvt_pk_bf16_f32 v25, v114, v115
    v_cvt_pk_bf16_f32 v26, v116, v117
    v_cvt_pk_bf16_f32 v27, v118, v119
    buffer_store_dwordx4 v[24:27], v47, s[32:35], 0 offen offset:0 sc1
    v_pk_mul_f32 v[120:121], v[120:121], v[46:47] op_sel_hi:[1,0]
    v_pk_mul_f32 v[122:123], v[122:123], v[46:47] op_sel_hi:[1,0]
    v_pk_mul_f32 v[124:125], v[124:125], v[46:47] op_sel_hi:[1,0]
    v_pk_mul_f32 v[126:127], v[126:127], v[46:47] op_sel_hi:[1,0]
    v_cvt_pk_bf16_f32 v28, v120, v121
    v_cvt_pk_bf16_f32 v29, v122, v123
    v_cvt_pk_bf16_f32 v30, v124, v125
    v_cvt_pk_bf16_f32 v31, v126, v127
    buffer_store_dwordx4 v[28:31], v47, s[32:35], 0 offen offset:512 sc1
    ds_read_b64_tr_b16 a[146:147], v16 offset:58368
    ds_read_b64_tr_b16 a[148:149], v17 offset:57344
    ds_read_b64_tr_b16 a[150:151], v17 offset:58368
    ds_read_b64_tr_b16 a[152:153], v18 offset:57344
    ds_read_b64_tr_b16 a[154:155], v18 offset:58368
    ds_read_b64_tr_b16 a[156:157], v19 offset:57344
    ds_read_b64_tr_b16 a[158:159], v19 offset:58368
    s_waitcnt vmcnt(12) lgkmcnt(8)
    v_mfma_f32_16x16x32_bf16 v[48:51], a[128:131], v[96:99], 0
    ds_read_b64_tr_b16 a[160:161], v16 offset:53248
    v_mfma_f32_16x16x32_bf16 v[52:55], a[128:131], v[100:103], 0
    ds_read_b64_tr_b16 a[162:163], v16 offset:54272
    s_add_u32 s8, s8, 4096
    s_addc_u32 s9, s9, 0
    buffer_load_dwordx4 v[168:171], v37, s[8:11], 0 offen offset:0 sc1
    v_mfma_f32_16x16x32_bf16 v[56:59], a[132:135], v[96:99], 0
    ds_read_b64_tr_b16 a[164:165], v17 offset:53248
    v_mfma_f32_16x16x32_bf16 v[60:63], a[132:135], v[100:103], 0
    ds_read_b64_tr_b16 a[166:167], v17 offset:54272
    buffer_load_dwordx4 v[172:175], v37, s[8:11], 0 offen offset:1024 sc1
    v_mfma_f32_16x16x32_bf16 v[64:67], a[136:139], v[96:99], 0
    ds_read_b64_tr_b16 a[168:169], v18 offset:53248
    v_mfma_f32_16x16x32_bf16 v[68:71], a[136:139], v[100:103], 0
    ds_read_b64_tr_b16 a[170:171], v18 offset:54272
    v_mfma_f32_16x16x32_bf16 v[72:75], a[140:143], v[96:99], 0
    ds_read_b64_tr_b16 a[172:173], v19 offset:53248
    v_mfma_f32_16x16x32_bf16 v[76:79], a[140:143], v[100:103], 0
    ds_read_b64_tr_b16 a[174:175], v19 offset:54272
    s_waitcnt vmcnt(12) lgkmcnt(8)
    v_mfma_f32_16x16x32_bf16 v[48:51], a[144:147], v[104:107], v[48:51]
    ds_read_b64_tr_b16 a[176:177], v16 offset:49152
    v_mfma_f32_16x16x32_bf16 v[52:55], a[144:147], v[108:111], v[52:55]
    ds_read_b64_tr_b16 a[178:179], v16 offset:50176
    buffer_load_dwordx4 v[176:179], v37, s[8:11], 0 offen offset:2048 sc1
    v_mfma_f32_16x16x32_bf16 v[56:59], a[148:151], v[104:107], v[56:59]
    ds_read_b64_tr_b16 a[180:181], v17 offset:49152
    v_mfma_f32_16x16x32_bf16 v[60:63], a[148:151], v[108:111], v[60:63]
    ds_read_b64_tr_b16 a[182:183], v17 offset:50176
    buffer_load_dwordx4 v[180:183], v37, s[8:11], 0 offen offset:3072 sc1
    v_mfma_f32_16x16x32_bf16 v[64:67], a[152:155], v[104:107], v[64:67]
    ds_read_b64_tr_b16 a[184:185], v18 offset:49152
    v_mfma_f32_16x16x32_bf16 v[68:71], a[152:155], v[108:111], v[68:71]
    ds_read_b64_tr_b16 a[186:187], v18 offset:50176
    v_mfma_f32_16x16x32_bf16 v[72:75], a[156:159], v[104:107], v[72:75]
    ds_read_b64_tr_b16 a[188:189], v19 offset:49152
    v_mfma_f32_16x16x32_bf16 v[76:79], a[156:159], v[108:111], v[76:79]
    ds_read_b64_tr_b16 a[190:191], v19 offset:50176
    s_waitcnt vmcnt(12) lgkmcnt(8)
    v_mfma_f32_16x16x32_bf16 v[48:51], a[160:163], v[136:139], v[48:51]
    ds_read_b64_tr_b16 a[192:193], v16 offset:45056
    v_mfma_f32_16x16x32_bf16 v[52:55], a[160:163], v[140:143], v[52:55]
    ds_read_b64_tr_b16 a[194:195], v16 offset:46080
    s_add_u32 s8, s8, 4096
    s_addc_u32 s9, s9, 0
    buffer_load_dwordx4 v[184:187], v37, s[8:11], 0 offen offset:0 sc1
    v_mfma_f32_16x16x32_bf16 v[56:59], a[164:167], v[136:139], v[56:59]
    ds_read_b64_tr_b16 a[196:197], v17 offset:45056
    v_mfma_f32_16x16x32_bf16 v[60:63], a[164:167], v[140:143], v[60:63]
    ds_read_b64_tr_b16 a[198:199], v17 offset:46080
    buffer_load_dwordx4 v[188:191], v37, s[8:11], 0 offen offset:1024 sc1
    v_mfma_f32_16x16x32_bf16 v[64:67], a[168:171], v[136:139], v[64:67]
    ds_read_b64_tr_b16 a[200:201], v18 offset:45056
    v_mfma_f32_16x16x32_bf16 v[68:71], a[168:171], v[140:143], v[68:71]
    ds_read_b64_tr_b16 a[202:203], v18 offset:46080
    v_mfma_f32_16x16x32_bf16 v[72:75], a[172:175], v[136:139], v[72:75]
    ds_read_b64_tr_b16 a[204:205], v19 offset:45056
    v_mfma_f32_16x16x32_bf16 v[76:79], a[172:175], v[140:143], v[76:79]
    ds_read_b64_tr_b16 a[206:207], v19 offset:46080
    s_waitcnt vmcnt(12) lgkmcnt(8)
    v_mfma_f32_16x16x32_bf16 v[48:51], a[176:179], v[144:147], v[48:51]
    ds_read_b64_tr_b16 a[208:209], v16 offset:40960
    v_mfma_f32_16x16x32_bf16 v[52:55], a[176:179], v[148:151], v[52:55]
    ds_read_b64_tr_b16 a[210:211], v16 offset:41984
    buffer_load_dwordx4 v[200:203], v37, s[8:11], 0 offen offset:2048 sc1
L_pad6:
    s_cbranch_execz L_pad7
    v_mfma_f32_16x16x32_bf16 v[56:59], a[180:183], v[144:147], v[56:59]
    ds_read_b64_tr_b16 a[212:213], v17 offset:40960
    v_mfma_f32_16x16x32_bf16 v[60:63], a[180:183], v[148:151], v[60:63]
    ds_read_b64_tr_b16 a[214:215], v17 offset:41984
    buffer_load_dwordx4 v[204:207], v37, s[8:11], 0 offen offset:3072 sc1
    v_mfma_f32_16x16x32_bf16 v[64:67], a[184:187], v[144:147], v[64:67]
    ds_read_b64_tr_b16 a[216:217], v18 offset:40960
    v_mfma_f32_16x16x32_bf16 v[68:71], a[184:187], v[148:151], v[68:71]
    ds_read_b64_tr_b16 a[218:219], v18 offset:41984
    v_mfma_f32_16x16x32_bf16 v[72:75], a[188:191], v[144:147], v[72:75]
    ds_read_b64_tr_b16 a[220:221], v19 offset:40960
    v_mfma_f32_16x16x32_bf16 v[76:79], a[188:191], v[148:151], v[76:79]
    ds_read_b64_tr_b16 a[222:223], v19 offset:41984
    s_waitcnt vmcnt(12) lgkmcnt(8)
    v_mfma_f32_16x16x32_bf16 v[48:51], a[192:195], v[152:155], v[48:51]
    ds_read_b64_tr_b16 a[128:129], v16 offset:36864
    v_mfma_f32_16x16x32_bf16 v[52:55], a[192:195], v[156:159], v[52:55]
    ds_read_b64_tr_b16 a[130:131], v16 offset:37888
    s_add_u32 s8, s8, 4096
    s_addc_u32 s9, s9, 0
    buffer_load_dwordx4 v[208:211], v37, s[8:11], 0 offen offset:0 sc1
    v_mfma_f32_16x16x32_bf16 v[56:59], a[196:199], v[152:155], v[56:59]
    ds_read_b64_tr_b16 a[132:133], v17 offset:36864
    v_mfma_f32_16x16x32_bf16 v[60:63], a[196:199], v[156:159], v[60:63]
    ds_read_b64_tr_b16 a[134:135], v17 offset:37888
    buffer_load_dwordx4 v[212:215], v37, s[8:11], 0 offen offset:1024 sc1
    v_mfma_f32_16x16x32_bf16 v[64:67], a[200:203], v[152:155], v[64:67]
    ds_read_b64_tr_b16 a[136:137], v18 offset:36864
    v_mfma_f32_16x16x32_bf16 v[68:71], a[200:203], v[156:159], v[68:71]
    ds_read_b64_tr_b16 a[138:139], v18 offset:37888
    v_mfma_f32_16x16x32_bf16 v[72:75], a[204:207], v[152:155], v[72:75]
    ds_read_b64_tr_b16 a[140:141], v19 offset:36864
    v_mfma_f32_16x16x32_bf16 v[76:79], a[204:207], v[156:159], v[76:79]
    ds_read_b64_tr_b16 a[142:143], v19 offset:37888
    s_waitcnt vmcnt(12) lgkmcnt(8)
    v_mfma_f32_16x16x32_bf16 v[48:51], a[208:211], v[160:163], v[48:51]
    ds_read_b64_tr_b16 a[144:145], v16 offset:32768
    v_mfma_f32_16x16x32_bf16 v[52:55], a[208:211], v[164:167], v[52:55]
    ds_read_b64_tr_b16 a[146:147], v16 offset:33792
    buffer_load_dwordx4 v[216:219], v37, s[8:11], 0 offen offset:2048 sc1
    v_mfma_f32_16x16x32_bf16 v[56:59], a[212:215], v[160:163], v[56:59]
    ds_read_b64_tr_b16 a[148:149], v17 offset:32768
    v_mfma_f32_16x16x32_bf16 v[60:63], a[212:215], v[164:167], v[60:63]
    ds_read_b64_tr_b16 a[150:151], v17 offset:33792
    buffer_load_dwordx4 v[220:223], v37, s[8:11], 0 offen offset:3072 sc1
    v_mfma_f32_16x16x32_bf16 v[64:67], a[216:219], v[160:163], v[64:67]
    ds_read_b64_tr_b16 a[152:153], v18 offset:32768
    v_mfma_f32_16x16x32_bf16 v[68:71], a[216:219], v[164:167], v[68:71]
    ds_read_b64_tr_b16 a[154:155], v18 offset:33792
    v_mfma_f32_16x16x32_bf16 v[72:75], a[220:223], v[160:163], v[72:75]
    ds_read_b64_tr_b16 a[156:157], v19 offset:32768
    v_mfma_f32_16x16x32_bf16 v[76:79], a[220:223], v[164:167], v[76:79]
    ds_read_b64_tr_b16 a[158:159], v19 offset:33792
    s_waitcnt vmcnt(10) lgkmcnt(8)
    v_mfma_f32_16x16x32_bf16 v[48:51], a[128:131], v[168:171], v[48:51]
    ds_read_b64_tr_b16 a[160:161], v16 offset:28672
    v_mfma_f32_16x16x32_bf16 v[52:55], a[128:131], v[172:175], v[52:55]
    ds_read_b64_tr_b16 a[162:163], v16 offset:29696
    s_add_u32 s8, s8, 4096
    s_addc_u32 s9, s9, 0
    buffer_load_dwordx4 v[224:227], v37, s[8:11], 0 offen offset:0 sc1
    v_mfma_f32_16x16x32_bf16 v[56:59], a[132:135], v[168:171], v[56:59]
    ds_read_b64_tr_b16 a[164:165], v17 offset:28672
    v_mfma_f32_16x16x32_bf16 v[60:63], a[132:135], v[172:175], v[60:63]
    ds_read_b64_tr_b16 a[166:167], v17 offset:29696
    buffer_load_dwordx4 v[228:231], v37, s[8:11], 0 offen offset:1024 sc1
    v_mfma_f32_16x16x32_bf16 v[64:67], a[136:139], v[168:171], v[64:67]
    ds_read_b64_tr_b16 a[168:169], v18 offset:28672
    v_mfma_f32_16x16x32_bf16 v[68:71], a[136:139], v[172:175], v[68:71]
    ds_read_b64_tr_b16 a[170:171], v18 offset:29696
    v_mfma_f32_16x16x32_bf16 v[72:75], a[140:143], v[168:171], v[72:75]
    ds_read_b64_tr_b16 a[172:173], v19 offset:28672
    v_mfma_f32_16x16x32_bf16 v[76:79], a[140:143], v[172:175], v[76:79]
    ds_read_b64_tr_b16 a[174:175], v19 offset:29696
    s_waitcnt vmcnt(10) lgkmcnt(8)
    v_mfma_f32_16x16x32_bf16 v[48:51], a[144:147], v[176:179], v[48:51]
    ds_read_b64_tr_b16 a[176:177], v16 offset:24576
    v_mfma_f32_16x16x32_bf16 v[52:55], a[144:147], v[180:183], v[52:55]
    ds_read_b64_tr_b16 a[178:179], v16 offset:25600
    s_mov_b32 s43, 32768
    buffer_load_dword v38, v10, s[32:35], s43 offen sc1
    v_mfma_f32_16x16x32_bf16 v[56:59], a[148:151], v[176:179], v[56:59]
    ds_read_b64_tr_b16 a[180:181], v17 offset:24576
    v_mfma_f32_16x16x32_bf16 v[60:63], a[148:151], v[180:183], v[60:63]
    ds_read_b64_tr_b16 a[182:183], v17 offset:25600
    buffer_load_dwordx4 v[232:235], v37, s[8:11], 0 offen offset:2048 sc1
    v_mfma_f32_16x16x32_bf16 v[64:67], a[152:155], v[176:179], v[64:67]
    ds_read_b64_tr_b16 a[184:185], v18 offset:24576
    v_mfma_f32_16x16x32_bf16 v[68:71], a[152:155], v[180:183], v[68:71]
    ds_read_b64_tr_b16 a[186:187], v18 offset:25600
    buffer_load_dwordx4 v[236:239], v37, s[8:11], 0 offen offset:3072 sc1
    v_mfma_f32_16x16x32_bf16 v[72:75], a[156:159], v[176:179], v[72:75]
    ds_read_b64_tr_b16 a[188:189], v19 offset:24576
    v_mfma_f32_16x16x32_bf16 v[76:79], a[156:159], v[180:183], v[76:79]
    ds_read_b64_tr_b16 a[190:191], v19 offset:25600
    s_waitcnt vmcnt(11) lgkmcnt(8)
    v_mfma_f32_16x16x32_bf16 v[48:51], a[160:163], v[184:187], v[48:51]
    ds_read_b64_tr_b16 a[192:193], v16 offset:20480
    v_mfma_f32_16x16x32_bf16 v[52:55], a[160:163], v[188:191], v[52:55]
    ds_read_b64_tr_b16 a[194:195], v16 offset:21504
    s_add_u32 s8, s8, 4096
    s_addc_u32 s9, s9, 0
    buffer_load_dwordx4 v[240:243], v37, s[8:11], 0 offen offset:0 sc1
    v_mfma_f32_16x16x32_bf16 v[56:59], a[164:167], v[184:187], v[56:59]
    ds_read_b64_tr_b16 a[196:197], v17 offset:20480
    v_mfma_f32_16x16x32_bf16 v[60:63], a[164:167], v[188:191], v[60:63]
    ds_read_b64_tr_b16 a[198:199], v17 offset:21504
    buffer_load_dwordx4 v[244:247], v37, s[8:11], 0 offen offset:1024 sc1
    v_mfma_f32_16x16x32_bf16 v[64:67], a[168:171], v[184:187], v[64:67]
    ds_read_b64_tr_b16 a[200:201], v18 offset:20480
    v_mfma_f32_16x16x32_bf16 v[68:71], a[168:171], v[188:191], v[68:71]
    ds_read_b64_tr_b16 a[202:203], v18 offset:21504
    v_mfma_f32_16x16x32_bf16 v[72:75], a[172:175], v[184:187], v[72:75]
    ds_read_b64_tr_b16 a[204:205], v19 offset:20480
    v_mfma_f32_16x16x32_bf16 v[76:79], a[172:175], v[188:191], v[76:79]
    ds_read_b64_tr_b16 a[206:207], v19 offset:21504
    s_waitcnt vmcnt(11) lgkmcnt(8)
    v_mfma_f32_16x16x32_bf16 v[48:51], a[176:179], v[200:203], v[48:51]
    ds_read_b64_tr_b16 a[208:209], v16 offset:16384
    v_mfma_f32_16x16x32_bf16 v[52:55], a[176:179], v[204:207], v[52:55]
    ds_read_b64_tr_b16 a[210:211], v16 offset:17408
    buffer_load_dwordx4 v[248:251], v37, s[8:11], 0 offen offset:2048 sc1
    v_mfma_f32_16x16x32_bf16 v[56:59], a[180:183], v[200:203], v[56:59]
    ds_read_b64_tr_b16 a[212:213], v17 offset:16384
    v_mfma_f32_16x16x32_bf16 v[60:63], a[180:183], v[204:207], v[60:63]
    ds_read_b64_tr_b16 a[214:215], v17 offset:17408
    buffer_load_dwordx4 v[252:255], v37, s[8:11], 0 offen offset:3072 sc1
    v_mfma_f32_16x16x32_bf16 v[64:67], a[184:187], v[200:203], v[64:67]
    ds_read_b64_tr_b16 a[216:217], v18 offset:16384
    v_mfma_f32_16x16x32_bf16 v[68:71], a[184:187], v[204:207], v[68:71]
    ds_read_b64_tr_b16 a[218:219], v18 offset:17408
    v_mfma_f32_16x16x32_bf16 v[72:75], a[188:191], v[200:203], v[72:75]
    ds_read_b64_tr_b16 a[220:221], v19 offset:16384
    v_mfma_f32_16x16x32_bf16 v[76:79], a[188:191], v[204:207], v[76:79]
    ds_read_b64_tr_b16 a[222:223], v19 offset:17408
    s_waitcnt vmcnt(11) lgkmcnt(8)
    v_mfma_f32_16x16x32_bf16 v[48:51], a[192:195], v[208:211], v[48:51]
    ds_read_b64_tr_b16 a[128:129], v16 offset:12288
    v_mfma_f32_16x16x32_bf16 v[52:55], a[192:195], v[212:215], v[52:55]
    ds_read_b64_tr_b16 a[130:131], v16 offset:13312
    v_mfma_f32_16x16x32_bf16 v[56:59], a[196:199], v[208:211], v[56:59]
    ds_read_b64_tr_b16 a[132:133], v17 offset:12288
    v_mfma_f32_16x16x32_bf16 v[60:63], a[196:199], v[212:215], v[60:63]
    ds_read_b64_tr_b16 a[134:135], v17 offset:13312
    v_mfma_f32_16x16x32_bf16 v[64:67], a[200:203], v[208:211], v[64:67]
    ds_read_b64_tr_b16 a[136:137], v18 offset:12288
    v_mfma_f32_16x16x32_bf16 v[68:71], a[200:203], v[212:215], v[68:71]
    ds_read_b64_tr_b16 a[138:139], v18 offset:13312
    v_mfma_f32_16x16x32_bf16 v[72:75], a[204:207], v[208:211], v[72:75]
    ds_read_b64_tr_b16 a[140:141], v19 offset:12288
    v_mfma_f32_16x16x32_bf16 v[76:79], a[204:207], v[212:215], v[76:79]
    ds_read_b64_tr_b16 a[142:143], v19 offset:13312
    s_waitcnt vmcnt(9) lgkmcnt(8)
    v_mfma_f32_16x16x32_bf16 v[48:51], a[208:211], v[216:219], v[48:51]
    ds_read_b64_tr_b16 a[144:145], v16 offset:8192
    v_mfma_f32_16x16x32_bf16 v[52:55], a[208:211], v[220:223], v[52:55]
    ds_read_b64_tr_b16 a[146:147], v16 offset:9216
    v_mfma_f32_16x16x32_bf16 v[56:59], a[212:215], v[216:219], v[56:59]
    ds_read_b64_tr_b16 a[148:149], v17 offset:8192
    v_mfma_f32_16x16x32_bf16 v[60:63], a[212:215], v[220:223], v[60:63]
    ds_read_b64_tr_b16 a[150:151], v17 offset:9216
    v_mfma_f32_16x16x32_bf16 v[64:67], a[216:219], v[216:219], v[64:67]
    ds_read_b64_tr_b16 a[152:153], v18 offset:8192
    v_mfma_f32_16x16x32_bf16 v[68:71], a[216:219], v[220:223], v[68:71]
    ds_read_b64_tr_b16 a[154:155], v18 offset:9216
    v_mfma_f32_16x16x32_bf16 v[72:75], a[220:223], v[216:219], v[72:75]
    ds_read_b64_tr_b16 a[156:157], v19 offset:8192
    v_mfma_f32_16x16x32_bf16 v[76:79], a[220:223], v[220:223], v[76:79]
    ds_read_b64_tr_b16 a[158:159], v19 offset:9216
    s_waitcnt vmcnt(7) lgkmcnt(8)
    v_mfma_f32_16x16x32_bf16 v[48:51], a[128:131], v[224:227], v[48:51]
    ds_read_b64_tr_b16 a[160:161], v16 offset:4096
    v_mfma_f32_16x16x32_bf16 v[52:55], a[128:131], v[228:231], v[52:55]
    ds_read_b64_tr_b16 a[162:163], v16 offset:5120
    s_waitcnt vmcnt(6)
    v_cmp_eq_u32 vcc, -1, v38
    v_mfma_f32_16x16x32_bf16 v[56:59], a[132:135], v[224:227], v[56:59]
    ds_read_b64_tr_b16 a[164:165], v17 offset:4096
    v_mfma_f32_16x16x32_bf16 v[60:63], a[132:135], v[228:231], v[60:63]
    ds_read_b64_tr_b16 a[166:167], v17 offset:5120
    s_cmp_lg_u64 vcc, 0
    s_cbranch_scc1 L_gate1__retry26
L_gate1__ok27:
    v_mfma_f32_16x16x32_bf16 v[64:67], a[136:139], v[224:227], v[64:67]
    ds_read_b64_tr_b16 a[168:169], v18 offset:4096
    v_mfma_f32_16x16x32_bf16 v[68:71], a[136:139], v[228:231], v[68:71]
    ds_read_b64_tr_b16 a[170:171], v18 offset:5120
    s_add_u32 s8, s8, 4096
    s_addc_u32 s9, s9, 0
    buffer_load_dwordx4 a[0:3], v37, s[8:11], 0 offen offset:0 sc1
    v_mfma_f32_16x16x32_bf16 v[72:75], a[140:143], v[224:227], v[72:75]
    ds_read_b64_tr_b16 a[172:173], v19 offset:4096
    v_mfma_f32_16x16x32_bf16 v[76:79], a[140:143], v[228:231], v[76:79]
    ds_read_b64_tr_b16 a[174:175], v19 offset:5120
    buffer_load_dwordx4 a[4:7], v37, s[8:11], 0 offen offset:1024 sc1
    buffer_load_dwordx4 a[8:11], v37, s[8:11], 0 offen offset:2048 sc1
    buffer_load_dwordx4 a[12:15], v37, s[8:11], 0 offen offset:3072 sc1
    s_waitcnt vmcnt(8) lgkmcnt(8)
    v_mfma_f32_16x16x32_bf16 v[48:51], a[144:147], v[232:235], v[48:51]
    ds_read_b64_tr_b16 a[176:177], v16 offset:0
    v_mfma_f32_16x16x32_bf16 v[52:55], a[144:147], v[236:239], v[52:55]
    ds_read_b64_tr_b16 a[178:179], v16 offset:1024
    s_add_u32 s8, s8, 4096
    s_addc_u32 s9, s9, 0
    buffer_load_dwordx4 a[16:19], v37, s[8:11], 0 offen offset:0 sc1
    v_mfma_f32_16x16x32_bf16 v[56:59], a[148:151], v[232:235], v[56:59]
    ds_read_b64_tr_b16 a[180:181], v17 offset:0
    v_mfma_f32_16x16x32_bf16 v[60:63], a[148:151], v[236:239], v[60:63]
    ds_read_b64_tr_b16 a[182:183], v17 offset:1024
    buffer_load_dwordx4 a[20:23], v37, s[8:11], 0 offen offset:1024 sc1
    v_mfma_f32_16x16x32_bf16 v[64:67], a[152:155], v[232:235], v[64:67]
    ds_read_b64_tr_b16 a[184:185], v18 offset:0
    v_mfma_f32_16x16x32_bf16 v[68:71], a[152:155], v[236:239], v[68:71]
    ds_read_b64_tr_b16 a[186:187], v18 offset:1024
    v_mfma_f32_16x16x32_bf16 v[72:75], a[156:159], v[232:235], v[72:75]
    ds_read_b64_tr_b16 a[188:189], v19 offset:0
    v_mfma_f32_16x16x32_bf16 v[76:79], a[156:159], v[236:239], v[76:79]
    ds_read_b64_tr_b16 a[190:191], v19 offset:1024
    s_waitcnt vmcnt(8) lgkmcnt(8)
    v_mfma_f32_16x16x32_bf16 v[48:51], a[160:163], v[240:243], v[48:51]
    ds_read_b64_tr_b16 a[192:193], v20 offset:61440
    v_mfma_f32_16x16x32_bf16 v[52:55], a[160:163], v[244:247], v[52:55]
    ds_read_b64_tr_b16 a[194:195], v20 offset:62464
    buffer_load_dwordx4 a[24:27], v37, s[8:11], 0 offen offset:2048 sc1
    v_mfma_f32_16x16x32_bf16 v[56:59], a[164:167], v[240:243], v[56:59]
    ds_read_b64_tr_b16 a[196:197], v21 offset:61440
    v_mfma_f32_16x16x32_bf16 v[60:63], a[164:167], v[244:247], v[60:63]
    ds_read_b64_tr_b16 a[198:199], v21 offset:62464
    buffer_load_dwordx4 a[28:31], v37, s[8:11], 0 offen offset:3072 sc1
    v_mfma_f32_16x16x32_bf16 v[64:67], a[168:171], v[240:243], v[64:67]
    ds_read_b64_tr_b16 a[200:201], v22 offset:61440
    v_mfma_f32_16x16x32_bf16 v[68:71], a[168:171], v[244:247], v[68:71]
    ds_read_b64_tr_b16 a[202:203], v22 offset:62464
    v_mfma_f32_16x16x32_bf16 v[72:75], a[172:175], v[240:243], v[72:75]
    ds_read_b64_tr_b16 a[204:205], v23 offset:61440
    v_mfma_f32_16x16x32_bf16 v[76:79], a[172:175], v[244:247], v[76:79]
    ds_read_b64_tr_b16 a[206:207], v23 offset:62464
    s_waitcnt vmcnt(8) lgkmcnt(8)
    v_mfma_f32_16x16x32_bf16 v[48:51], a[176:179], v[248:251], v[48:51]
    ds_read_b64_tr_b16 a[208:209], v20 offset:57344
    v_mfma_f32_16x16x32_bf16 v[52:55], a[176:179], v[252:255], v[52:55]
    ds_read_b64_tr_b16 a[210:211], v20 offset:58368
    s_add_u32 s8, s8, 4096
    s_addc_u32 s9, s9, 0
    buffer_load_dwordx4 a[32:35], v37, s[8:11], 0 offen offset:0 sc1
    v_mfma_f32_16x16x32_bf16 v[56:59], a[180:183], v[248:251], v[56:59]
    ds_read_b64_tr_b16 a[212:213], v21 offset:57344
    v_mfma_f32_16x16x32_bf16 v[60:63], a[180:183], v[252:255], v[60:63]
    ds_read_b64_tr_b16 a[214:215], v21 offset:58368
    buffer_load_dwordx4 a[36:39], v37, s[8:11], 0 offen offset:1024 sc1
    v_mfma_f32_16x16x32_bf16 v[64:67], a[184:187], v[248:251], v[64:67]
    ds_read_b64_tr_b16 a[216:217], v22 offset:57344
    v_mfma_f32_16x16x32_bf16 v[68:71], a[184:187], v[252:255], v[68:71]
    ds_read_b64_tr_b16 a[218:219], v22 offset:58368
    v_mfma_f32_16x16x32_bf16 v[72:75], a[188:191], v[248:251], v[72:75]
    ds_read_b64_tr_b16 a[220:221], v23 offset:57344
    v_mfma_f32_16x16x32_bf16 v[76:79], a[188:191], v[252:255], v[76:79]
    ds_read_b64_tr_b16 a[222:223], v23 offset:58368
    s_waitcnt vmcnt(8) lgkmcnt(8)
    v_mfma_f32_16x16x32_bf16 v[48:51], a[192:195], a[0:3], v[48:51]
    ds_read_b64_tr_b16 a[128:129], v20 offset:53248
    v_mfma_f32_16x16x32_bf16 v[52:55], a[192:195], a[4:7], v[52:55]
    ds_read_b64_tr_b16 a[130:131], v20 offset:54272
    buffer_load_dwordx4 a[40:43], v37, s[8:11], 0 offen offset:2048 sc1
    v_mfma_f32_16x16x32_bf16 v[56:59], a[196:199], a[0:3], v[56:59]
    ds_read_b64_tr_b16 a[132:133], v21 offset:53248
    v_mfma_f32_16x16x32_bf16 v[60:63], a[196:199], a[4:7], v[60:63]
    ds_read_b64_tr_b16 a[134:135], v21 offset:54272
    buffer_load_dwordx4 a[44:47], v37, s[8:11], 0 offen offset:3072 sc1
    v_mfma_f32_16x16x32_bf16 v[64:67], a[200:203], a[0:3], v[64:67]
    ds_read_b64_tr_b16 a[136:137], v22 offset:53248
    v_mfma_f32_16x16x32_bf16 v[68:71], a[200:203], a[4:7], v[68:71]
    ds_read_b64_tr_b16 a[138:139], v22 offset:54272
    v_mfma_f32_16x16x32_bf16 v[72:75], a[204:207], a[0:3], v[72:75]
    ds_read_b64_tr_b16 a[140:141], v23 offset:53248
    v_mfma_f32_16x16x32_bf16 v[76:79], a[204:207], a[4:7], v[76:79]
    ds_read_b64_tr_b16 a[142:143], v23 offset:54272
    s_waitcnt vmcnt(8) lgkmcnt(8)
    v_mfma_f32_16x16x32_bf16 v[48:51], a[208:211], a[8:11], v[48:51]
    ds_read_b64_tr_b16 a[144:145], v20 offset:49152
    v_mfma_f32_16x16x32_bf16 v[52:55], a[208:211], a[12:15], v[52:55]
    ds_read_b64_tr_b16 a[146:147], v20 offset:50176
    s_add_u32 s8, s8, 4096
    s_addc_u32 s9, s9, 0
    buffer_load_dwordx4 a[48:51], v37, s[8:11], 0 offen offset:0 sc1
    v_mfma_f32_16x16x32_bf16 v[56:59], a[212:215], a[8:11], v[56:59]
    ds_read_b64_tr_b16 a[148:149], v21 offset:49152
    v_mfma_f32_16x16x32_bf16 v[60:63], a[212:215], a[12:15], v[60:63]
    ds_read_b64_tr_b16 a[150:151], v21 offset:50176
    buffer_load_dwordx4 a[52:55], v37, s[8:11], 0 offen offset:1024 sc1
    v_mfma_f32_16x16x32_bf16 v[64:67], a[216:219], a[8:11], v[64:67]
    ds_read_b64_tr_b16 a[152:153], v22 offset:49152
    v_mfma_f32_16x16x32_bf16 v[68:71], a[216:219], a[12:15], v[68:71]
    ds_read_b64_tr_b16 a[154:155], v22 offset:50176
    v_mfma_f32_16x16x32_bf16 v[72:75], a[220:223], a[8:11], v[72:75]
    ds_read_b64_tr_b16 a[156:157], v23 offset:49152
    v_mfma_f32_16x16x32_bf16 v[76:79], a[220:223], a[12:15], v[76:79]
    ds_read_b64_tr_b16 a[158:159], v23 offset:50176
    s_waitcnt vmcnt(8) lgkmcnt(8)
    v_mfma_f32_16x16x32_bf16 v[48:51], a[128:131], a[16:19], v[48:51]
    ds_read_b64_tr_b16 a[160:161], v20 offset:45056
    v_mfma_f32_16x16x32_bf16 v[52:55], a[128:131], a[20:23], v[52:55]
    ds_read_b64_tr_b16 a[162:163], v20 offset:46080
    buffer_load_dwordx4 a[56:59], v37, s[8:11], 0 offen offset:2048 sc1
    v_mfma_f32_16x16x32_bf16 v[56:59], a[132:135], a[16:19], v[56:59]
    ds_read_b64_tr_b16 a[164:165], v21 offset:45056
    v_mfma_f32_16x16x32_bf16 v[60:63], a[132:135], a[20:23], v[60:63]
    ds_read_b64_tr_b16 a[166:167], v21 offset:46080
    buffer_load_dwordx4 a[60:63], v37, s[8:11], 0 offen offset:3072 sc1
    v_mfma_f32_16x16x32_bf16 v[64:67], a[136:139], a[16:19], v[64:67]
    ds_read_b64_tr_b16 a[168:169], v22 offset:45056
    v_mfma_f32_16x16x32_bf16 v[68:71], a[136:139], a[20:23], v[68:71]
    ds_read_b64_tr_b16 a[170:171], v22 offset:46080
    v_mfma_f32_16x16x32_bf16 v[72:75], a[140:143], a[16:19], v[72:75]
    ds_read_b64_tr_b16 a[172:173], v23 offset:45056
    v_mfma_f32_16x16x32_bf16 v[76:79], a[140:143], a[20:23], v[76:79]
    ds_read_b64_tr_b16 a[174:175], v23 offset:46080
    s_waitcnt vmcnt(8) lgkmcnt(8)
    v_mfma_f32_16x16x32_bf16 v[48:51], a[144:147], a[24:27], v[48:51]
    ds_read_b64_tr_b16 a[176:177], v20 offset:40960
    v_mfma_f32_16x16x32_bf16 v[52:55], a[144:147], a[28:31], v[52:55]
    ds_read_b64_tr_b16 a[178:179], v20 offset:41984
    s_add_u32 s8, s8, 4096
    s_addc_u32 s9, s9, 0
    buffer_load_dwordx4 a[64:67], v37, s[8:11], 0 offen offset:0 sc1
    v_mfma_f32_16x16x32_bf16 v[56:59], a[148:151], a[24:27], v[56:59]
    ds_read_b64_tr_b16 a[180:181], v21 offset:40960
    v_mfma_f32_16x16x32_bf16 v[60:63], a[148:151], a[28:31], v[60:63]
    ds_read_b64_tr_b16 a[182:183], v21 offset:41984
    buffer_load_dwordx4 a[68:71], v37, s[8:11], 0 offen offset:1024 sc1
    v_mfma_f32_16x16x32_bf16 v[64:67], a[152:155], a[24:27], v[64:67]
    ds_read_b64_tr_b16 a[184:185], v22 offset:40960
    v_mfma_f32_16x16x32_bf16 v[68:71], a[152:155], a[28:31], v[68:71]
    ds_read_b64_tr_b16 a[186:187], v22 offset:41984
    v_mfma_f32_16x16x32_bf16 v[72:75], a[156:159], a[24:27], v[72:75]
    ds_read_b64_tr_b16 a[188:189], v23 offset:40960
    v_mfma_f32_16x16x32_bf16 v[76:79], a[156:159], a[28:31], v[76:79]
    ds_read_b64_tr_b16 a[190:191], v23 offset:41984
    s_waitcnt vmcnt(8) lgkmcnt(8)
    v_mfma_f32_16x16x32_bf16 v[48:51], a[160:163], a[32:35], v[48:51]
    ds_read_b64_tr_b16 a[192:193], v20 offset:36864
    v_mfma_f32_16x16x32_bf16 v[52:55], a[160:163], a[36:39], v[52:55]
    ds_read_b64_tr_b16 a[194:195], v20 offset:37888
    buffer_load_dwordx4 a[72:75], v37, s[8:11], 0 offen offset:2048 sc1
    v_mfma_f32_16x16x32_bf16 v[56:59], a[164:167], a[32:35], v[56:59]
    ds_read_b64_tr_b16 a[196:197], v21 offset:36864
    v_mfma_f32_16x16x32_bf16 v[60:63], a[164:167], a[36:39], v[60:63]
    ds_read_b64_tr_b16 a[198:199], v21 offset:37888
    buffer_load_dwordx4 a[76:79], v37, s[8:11], 0 offen offset:3072 sc1
    v_mfma_f32_16x16x32_bf16 v[64:67], a[168:171], a[32:35], v[64:67]
    ds_read_b64_tr_b16 a[200:201], v22 offset:36864
    v_mfma_f32_16x16x32_bf16 v[68:71], a[168:171], a[36:39], v[68:71]
    ds_read_b64_tr_b16 a[202:203], v22 offset:37888
    v_mfma_f32_16x16x32_bf16 v[72:75], a[172:175], a[32:35], v[72:75]
    ds_read_b64_tr_b16 a[204:205], v23 offset:36864
    v_mfma_f32_16x16x32_bf16 v[76:79], a[172:175], a[36:39], v[76:79]
    ds_read_b64_tr_b16 a[206:207], v23 offset:37888
    s_waitcnt vmcnt(8) lgkmcnt(8)
    v_mfma_f32_16x16x32_bf16 v[48:51], a[176:179], a[40:43], v[48:51]
    ds_read_b64_tr_b16 a[208:209], v20 offset:32768
    v_mfma_f32_16x16x32_bf16 v[52:55], a[176:179], a[44:47], v[52:55]
    ds_read_b64_tr_b16 a[210:211], v20 offset:33792
    s_add_u32 s8, s8, 4096
    s_addc_u32 s9, s9, 0
    buffer_load_dwordx4 a[80:83], v37, s[8:11], 0 offen offset:0 sc1
    v_mfma_f32_16x16x32_bf16 v[56:59], a[180:183], a[40:43], v[56:59]
    ds_read_b64_tr_b16 a[212:213], v21 offset:32768
    v_mfma_f32_16x16x32_bf16 v[60:63], a[180:183], a[44:47], v[60:63]
    ds_read_b64_tr_b16 a[214:215], v21 offset:33792
    buffer_load_dwordx4 a[84:87], v37, s[8:11], 0 offen offset:1024 sc1
    v_mfma_f32_16x16x32_bf16 v[64:67], a[184:187], a[40:43], v[64:67]
    ds_read_b64_tr_b16 a[216:217], v22 offset:32768
    v_mfma_f32_16x16x32_bf16 v[68:71], a[184:187], a[44:47], v[68:71]
    ds_read_b64_tr_b16 a[218:219], v22 offset:33792
    v_mfma_f32_16x16x32_bf16 v[72:75], a[188:191], a[40:43], v[72:75]
    ds_read_b64_tr_b16 a[220:221], v23 offset:32768
    v_mfma_f32_16x16x32_bf16 v[76:79], a[188:191], a[44:47], v[76:79]
    ds_read_b64_tr_b16 a[222:223], v23 offset:33792
    s_waitcnt vmcnt(8) lgkmcnt(8)
    v_mfma_f32_16x16x32_bf16 v[48:51], a[192:195], a[48:51], v[48:51]
    ds_read_b64_tr_b16 a[128:129], v20 offset:28672
    v_mfma_f32_16x16x32_bf16 v[52:55], a[192:195], a[52:55], v[52:55]
    ds_read_b64_tr_b16 a[130:131], v20 offset:29696
    buffer_load_dwordx4 a[88:91], v37, s[8:11], 0 offen offset:2048 sc1
    v_mfma_f32_16x16x32_bf16 v[56:59], a[196:199], a[48:51], v[56:59]
    ds_read_b64_tr_b16 a[132:133], v21 offset:28672
    v_mfma_f32_16x16x32_bf16 v[60:63], a[196:199], a[52:55], v[60:63]
    ds_read_b64_tr_b16 a[134:135], v21 offset:29696
    buffer_load_dwordx4 a[92:95], v37, s[8:11], 0 offen offset:3072 sc1
    v_mfma_f32_16x16x32_bf16 v[64:67], a[200:203], a[48:51], v[64:67]
    ds_read_b64_tr_b16 a[136:137], v22 offset:28672
    v_mfma_f32_16x16x32_bf16 v[68:71], a[200:203], a[52:55], v[68:71]
    ds_read_b64_tr_b16 a[138:139], v22 offset:29696
    v_mfma_f32_16x16x32_bf16 v[72:75], a[204:207], a[48:51], v[72:75]
    ds_read_b64_tr_b16 a[140:141], v23 offset:28672
    v_mfma_f32_16x16x32_bf16 v[76:79], a[204:207], a[52:55], v[76:79]
    ds_read_b64_tr_b16 a[142:143], v23 offset:29696
    s_waitcnt vmcnt(8) lgkmcnt(8)
    v_mfma_f32_16x16x32_bf16 v[48:51], a[208:211], a[56:59], v[48:51]
    ds_read_b64_tr_b16 a[144:145], v20 offset:24576
    v_mfma_f32_16x16x32_bf16 v[52:55], a[208:211], a[60:63], v[52:55]
    ds_read_b64_tr_b16 a[146:147], v20 offset:25600
    s_add_u32 s8, s8, 4096
    s_addc_u32 s9, s9, 0
    buffer_load_dwordx4 a[96:99], v37, s[8:11], 0 offen offset:0 sc1
    v_mfma_f32_16x16x32_bf16 v[56:59], a[212:215], a[56:59], v[56:59]
    ds_read_b64_tr_b16 a[148:149], v21 offset:24576
    v_mfma_f32_16x16x32_bf16 v[60:63], a[212:215], a[60:63], v[60:63]
    ds_read_b64_tr_b16 a[150:151], v21 offset:25600
    buffer_load_dwordx4 a[100:103], v37, s[8:11], 0 offen offset:1024 sc1
    v_mfma_f32_16x16x32_bf16 v[64:67], a[216:219], a[56:59], v[64:67]
    ds_read_b64_tr_b16 a[152:153], v22 offset:24576
    v_mfma_f32_16x16x32_bf16 v[68:71], a[216:219], a[60:63], v[68:71]
    ds_read_b64_tr_b16 a[154:155], v22 offset:25600
    v_mfma_f32_16x16x32_bf16 v[72:75], a[220:223], a[56:59], v[72:75]
    ds_read_b64_tr_b16 a[156:157], v23 offset:24576
    v_mfma_f32_16x16x32_bf16 v[76:79], a[220:223], a[60:63], v[76:79]
    ds_read_b64_tr_b16 a[158:159], v23 offset:25600
    s_waitcnt vmcnt(8) lgkmcnt(8)
    v_mfma_f32_16x16x32_bf16 v[48:51], a[128:131], a[64:67], v[48:51]
    ds_read_b64_tr_b16 a[160:161], v20 offset:20480
    v_mfma_f32_16x16x32_bf16 v[52:55], a[128:131], a[68:71], v[52:55]
    ds_read_b64_tr_b16 a[162:163], v20 offset:21504
    buffer_load_dwordx4 a[104:107], v37, s[8:11], 0 offen offset:2048 sc1
    v_mfma_f32_16x16x32_bf16 v[56:59], a[132:135], a[64:67], v[56:59]
    ds_read_b64_tr_b16 a[164:165], v21 offset:20480
    v_mfma_f32_16x16x32_bf16 v[60:63], a[132:135], a[68:71], v[60:63]
    ds_read_b64_tr_b16 a[166:167], v21 offset:21504
    buffer_load_dwordx4 a[108:111], v37, s[8:11], 0 offen offset:3072 sc1
    v_mfma_f32_16x16x32_bf16 v[64:67], a[136:139], a[64:67], v[64:67]
    ds_read_b64_tr_b16 a[168:169], v22 offset:20480
    v_mfma_f32_16x16x32_bf16 v[68:71], a[136:139], a[68:71], v[68:71]
    ds_read_b64_tr_b16 a[170:171], v22 offset:21504
    v_mfma_f32_16x16x32_bf16 v[72:75], a[140:143], a[64:67], v[72:75]
    ds_read_b64_tr_b16 a[172:173], v23 offset:20480
    v_mfma_f32_16x16x32_bf16 v[76:79], a[140:143], a[68:71], v[76:79]
    ds_read_b64_tr_b16 a[174:175], v23 offset:21504
    s_waitcnt vmcnt(8) lgkmcnt(8)
    v_mfma_f32_16x16x32_bf16 v[48:51], a[144:147], a[72:75], v[48:51]
    ds_read_b64_tr_b16 a[176:177], v20 offset:16384
    v_mfma_f32_16x16x32_bf16 v[52:55], a[144:147], a[76:79], v[52:55]
    ds_read_b64_tr_b16 a[178:179], v20 offset:17408
    s_add_u32 s8, s8, 4096
    s_addc_u32 s9, s9, 0
    buffer_load_dwordx4 a[112:115], v37, s[8:11], 0 offen offset:0 sc1
    v_mfma_f32_16x16x32_bf16 v[56:59], a[148:151], a[72:75], v[56:59]
    ds_read_b64_tr_b16 a[180:181], v21 offset:16384
    v_mfma_f32_16x16x32_bf16 v[60:63], a[148:151], a[76:79], v[60:63]
    ds_read_b64_tr_b16 a[182:183], v21 offset:17408
    buffer_load_dwordx4 a[116:119], v37, s[8:11], 0 offen offset:1024 sc1
    v_mfma_f32_16x16x32_bf16 v[64:67], a[152:155], a[72:75], v[64:67]
    ds_read_b64_tr_b16 a[184:185], v22 offset:16384
    v_mfma_f32_16x16x32_bf16 v[68:71], a[152:155], a[76:79], v[68:71]
    ds_read_b64_tr_b16 a[186:187], v22 offset:17408
    v_mfma_f32_16x16x32_bf16 v[72:75], a[156:159], a[72:75], v[72:75]
    ds_read_b64_tr_b16 a[188:189], v23 offset:16384
    v_mfma_f32_16x16x32_bf16 v[76:79], a[156:159], a[76:79], v[76:79]
    ds_read_b64_tr_b16 a[190:191], v23 offset:17408
    s_waitcnt vmcnt(8) lgkmcnt(8)
    v_mfma_f32_16x16x32_bf16 v[48:51], a[160:163], a[80:83], v[48:51]
    ds_read_b64_tr_b16 a[192:193], v20 offset:12288
    v_mfma_f32_16x16x32_bf16 v[52:55], a[160:163], a[84:87], v[52:55]
    ds_read_b64_tr_b16 a[194:195], v20 offset:13312
    buffer_load_dwordx4 a[120:123], v37, s[8:11], 0 offen offset:2048 sc1
    v_mfma_f32_16x16x32_bf16 v[56:59], a[164:167], a[80:83], v[56:59]
    ds_read_b64_tr_b16 a[196:197], v21 offset:12288
    v_mfma_f32_16x16x32_bf16 v[60:63], a[164:167], a[84:87], v[60:63]
    ds_read_b64_tr_b16 a[198:199], v21 offset:13312
    buffer_load_dwordx4 a[124:127], v37, s[8:11], 0 offen offset:3072 sc1
    v_mfma_f32_16x16x32_bf16 v[64:67], a[168:171], a[80:83], v[64:67]
    ds_read_b64_tr_b16 a[200:201], v22 offset:12288
    v_mfma_f32_16x16x32_bf16 v[68:71], a[168:171], a[84:87], v[68:71]
    ds_read_b64_tr_b16 a[202:203], v22 offset:13312
    v_mfma_f32_16x16x32_bf16 v[72:75], a[172:175], a[80:83], v[72:75]
    ds_read_b64_tr_b16 a[204:205], v23 offset:12288
    v_mfma_f32_16x16x32_bf16 v[76:79], a[172:175], a[84:87], v[76:79]
    ds_read_b64_tr_b16 a[206:207], v23 offset:13312
    s_waitcnt vmcnt(8) lgkmcnt(8)
    v_mfma_f32_16x16x32_bf16 v[48:51], a[176:179], a[88:91], v[48:51]
    ds_read_b64_tr_b16 a[208:209], v20 offset:8192
    v_mfma_f32_16x16x32_bf16 v[52:55], a[176:179], a[92:95], v[52:55]
    ds_read_b64_tr_b16 a[210:211], v20 offset:9216
    v_mfma_f32_16x16x32_bf16 v[56:59], a[180:183], a[88:91], v[56:59]
    ds_read_b64_tr_b16 a[212:213], v21 offset:8192
    v_mfma_f32_16x16x32_bf16 v[60:63], a[180:183], a[92:95], v[60:63]
    ds_read_b64_tr_b16 a[214:215], v21 offset:9216
    v_mfma_f32_16x16x32_bf16 v[64:67], a[184:187], a[88:91], v[64:67]
    ds_read_b64_tr_b16 a[216:217], v22 offset:8192
    v_mfma_f32_16x16x32_bf16 v[68:71], a[184:187], a[92:95], v[68:71]
    ds_read_b64_tr_b16 a[218:219], v22 offset:9216
    v_mfma_f32_16x16x32_bf16 v[72:75], a[188:191], a[88:91], v[72:75]
    ds_read_b64_tr_b16 a[220:221], v23 offset:8192
    v_mfma_f32_16x16x32_bf16 v[76:79], a[188:191], a[92:95], v[76:79]
    ds_read_b64_tr_b16 a[222:223], v23 offset:9216
    s_waitcnt vmcnt(6) lgkmcnt(8)
    v_mfma_f32_16x16x32_bf16 v[48:51], a[192:195], a[96:99], v[48:51]
    ds_read_b64_tr_b16 a[128:129], v20 offset:4096
    v_mfma_f32_16x16x32_bf16 v[52:55], a[192:195], a[100:103], v[52:55]
    ds_read_b64_tr_b16 a[130:131], v20 offset:5120
    v_mfma_f32_16x16x32_bf16 v[56:59], a[196:199], a[96:99], v[56:59]
    ds_read_b64_tr_b16 a[132:133], v21 offset:4096
    v_mfma_f32_16x16x32_bf16 v[60:63], a[196:199], a[100:103], v[60:63]
    ds_read_b64_tr_b16 a[134:135], v21 offset:5120
    v_mfma_f32_16x16x32_bf16 v[64:67], a[200:203], a[96:99], v[64:67]
    ds_read_b64_tr_b16 a[136:137], v22 offset:4096
    v_mfma_f32_16x16x32_bf16 v[68:71], a[200:203], a[100:103], v[68:71]
    ds_read_b64_tr_b16 a[138:139], v22 offset:5120
    v_mfma_f32_16x16x32_bf16 v[72:75], a[204:207], a[96:99], v[72:75]
    ds_read_b64_tr_b16 a[140:141], v23 offset:4096
    v_mfma_f32_16x16x32_bf16 v[76:79], a[204:207], a[100:103], v[76:79]
    ds_read_b64_tr_b16 a[142:143], v23 offset:5120
    s_waitcnt vmcnt(4) lgkmcnt(8)
    v_mfma_f32_16x16x32_bf16 v[48:51], a[208:211], a[104:107], v[48:51]
    ds_read_b64_tr_b16 a[144:145], v20 offset:0
    v_mfma_f32_16x16x32_bf16 v[52:55], a[208:211], a[108:111], v[52:55]
    ds_read_b64_tr_b16 a[146:147], v20 offset:1024
    v_mfma_f32_16x16x32_bf16 v[56:59], a[212:215], a[104:107], v[56:59]
    ds_read_b64_tr_b16 a[148:149], v21 offset:0
    v_mfma_f32_16x16x32_bf16 v[60:63], a[212:215], a[108:111], v[60:63]
    ds_read_b64_tr_b16 a[150:151], v21 offset:1024
    v_mfma_f32_16x16x32_bf16 v[64:67], a[216:219], a[104:107], v[64:67]
    ds_read_b64_tr_b16 a[152:153], v22 offset:0
    v_mfma_f32_16x16x32_bf16 v[68:71], a[216:219], a[108:111], v[68:71]
    ds_read_b64_tr_b16 a[154:155], v22 offset:1024
    v_mfma_f32_16x16x32_bf16 v[72:75], a[220:223], a[104:107], v[72:75]
    ds_read_b64_tr_b16 a[156:157], v23 offset:0
    v_mfma_f32_16x16x32_bf16 v[76:79], a[220:223], a[108:111], v[76:79]
    ds_read_b64_tr_b16 a[158:159], v23 offset:1024
    s_waitcnt vmcnt(2) lgkmcnt(8)
    v_mfma_f32_16x16x32_bf16 v[48:51], a[128:131], a[112:115], v[48:51]
    v_mfma_f32_16x16x32_bf16 v[52:55], a[128:131], a[116:119], v[52:55]
    v_mfma_f32_16x16x32_bf16 v[56:59], a[132:135], a[112:115], v[56:59]
    v_mfma_f32_16x16x32_bf16 v[60:63], a[132:135], a[116:119], v[60:63]
L_pad7:
    s_cbranch_execz L_padback
    v_mfma_f32_16x16x32_bf16 v[64:67], a[136:139], a[112:115], v[64:67]
    v_mfma_f32_16x16x32_bf16 v[68:71], a[136:139], a[116:119], v[68:71]
    v_mfma_f32_16x16x32_bf16 v[72:75], a[140:143], a[112:115], v[72:75]
    v_mfma_f32_16x16x32_bf16 v[76:79], a[140:143], a[116:119], v[76:79]
    s_waitcnt vmcnt(0) lgkmcnt(0)
    v_mfma_f32_16x16x32_bf16 v[48:51], a[144:147], a[120:123], v[48:51]
    v_mfma_f32_16x16x32_bf16 v[52:55], a[144:147], a[124:127], v[52:55]
    v_mfma_f32_16x16x32_bf16 v[56:59], a[148:151], a[120:123], v[56:59]
    v_mfma_f32_16x16x32_bf16 v[60:63], a[148:151], a[124:127], v[60:63]
    v_mfma_f32_16x16x32_bf16 v[64:67], a[152:155], a[120:123], v[64:67]
    v_mfma_f32_16x16x32_bf16 v[68:71], a[152:155], a[124:127], v[68:71]
    v_mfma_f32_16x16x32_bf16 v[72:75], a[156:159], a[120:123], v[72:75]
    v_mfma_f32_16x16x32_bf16 v[76:79], a[156:159], a[124:127], v[76:79]
    s_nop 1
    v_cmp_u_f32 vcc, v48, v48
    v_cvt_pk_bf16_f32 v48, v48, v49
    v_cvt_pk_bf16_f32 v49, v50, v51
    ds_write_b64 v11, v[48:49] offset:0
    v_cvt_pk_bf16_f32 v56, v56, v57
    v_cvt_pk_bf16_f32 v57, v58, v59
    ds_write_b64 v11, v[56:57] offset:32
    v_cvt_pk_bf16_f32 v64, v64, v65
    v_cvt_pk_bf16_f32 v65, v66, v67
    ds_write_b64 v11, v[64:65] offset:64
    v_cvt_pk_bf16_f32 v72, v72, v73
    v_cvt_pk_bf16_f32 v73, v74, v75
    ds_write_b64 v11, v[72:73] offset:96
    ds_read_b128 v[80:83], v12 offset:0
    ds_read_b128 v[84:87], v12 offset:1152
    s_cmp_lg_u64 vcc, 0
    s_cbranch_scc1 L_slow
    s_waitcnt lgkmcnt(1)
    buffer_store_dwordx4 v[80:83], v13, s[20:23], 0 offen sc0 sc1
    s_mov_b32 s40, 16384
    s_waitcnt lgkmcnt(0)
    buffer_store_dwordx4 v[84:87], v13, s[20:23], s40 offen sc0 sc1
    s_nop 3
    v_cmp_u_f32 vcc, v52, v52
    v_cvt_pk_bf16_f32 v52, v52, v53
    v_cvt_pk_bf16_f32 v53, v54, v55
    ds_write_b64 v11, v[52:53] offset:2304
    v_cvt_pk_bf16_f32 v60, v60, v61
    v_cvt_pk_bf16_f32 v61, v62, v63
    ds_write_b64 v11, v[60:61] offset:2336
    v_cvt_pk_bf16_f32 v68, v68, v69
    v_cvt_pk_bf16_f32 v69, v70, v71
    ds_write_b64 v11, v[68:69] offset:2368
    v_cvt_pk_bf16_f32 v76, v76, v77
    v_cvt_pk_bf16_f32 v77, v78, v79
    ds_write_b64 v11, v[76:77] offset:2400
    ds_read_b128 v[88:91], v12 offset:2304
    ds_read_b128 v[92:95], v12 offset:3456
    s_cmp_lg_u64 vcc, 0
    s_cbranch_scc1 L_slow
    s_mov_b32 s40, 32768
    s_waitcnt lgkmcnt(1)
    buffer_store_dwordx4 v[88:91], v13, s[20:23], s40 offen sc0 sc1
    s_mov_b32 s40, 49152
    s_waitcnt lgkmcnt(0)
    buffer_store_dwordx4 v[92:95], v13, s[20:23], s40 offen sc0 sc1
L_done:
    s_endpgm
L_repoll5:
    buffer_load_dword v38, v37, s[24:27], s43 offen sc1
    s_branch L_repollret6
L_kv_retry7:
    s_mov_b32 s45, 0
L_kv_loop9:
    buffer_load_dword v38, v37, s[24:27], s43 offen sc1
    s_add_u32 s45, s45, 1
    s_cmp_gt_u32 s45, 2097152
    s_waitcnt vmcnt(0)
    s_cbranch_scc1 L_kv_ok8
    v_and_b32 v1, -2, v38
    v_cmp_ne_u32 vcc, s3, v1
    s_cmp_lg_u64 vcc, 0
    s_cbranch_scc1 L_kv_loop9
    s_branch L_kv_ok8
L_poison10:
    v_mov_b32 v40, 0x7fc07fc0
    v_mov_b32 v41, 0x7fc07fc0
    v_mov_b32 v42, 0x7fc07fc0
    v_mov_b32 v43, 0x7fc07fc0
    s_branch L_poisonret11
L_c2__retry12:
    s_mov_b32 s45, 0
L_c2__loop14:
    buffer_load_dword v38, v39, s[24:27], 0 offen offset:4 sc1
    s_add_u32 s45, s45, 1
    s_cmp_gt_u32 s45, 2097152
    s_waitcnt vmcnt(0)
    s_cbranch_scc1 L_c2__ok13
    v_cmp_ne_u32 vcc, s3, v38
    s_cmp_lg_u64 vcc, 0
    s_cbranch_scc1 L_c2__loop14
    s_branch L_c2__ok13
L_fb15:
    s_nop 15
    v_mov_b32 v248, 0xff800000
    s_mov_b32 s69, 0
L_fbmax17:
    buffer_load_dwordx4 v[200:203], v37, s[28:31], s69 offen offset:0 sc1
    buffer_load_dwordx4 v[204:207], v37, s[28:31], s69 offen offset:1024 sc1
    s_waitcnt vmcnt(0)
    v_mfma_f32_32x32x16_bf16 v[216:231], v[200:203], v[184:187], 0
    v_mfma_f32_32x32x16_bf16 v[216:231], v[204:207], v[188:191], v[216:231]
    s_nop 15
    v_max3_f32 v248, v248, v216, v217
    v_max3_f32 v248, v248, v218, v219
    v_max3_f32 v248, v248, v220, v221
    v_max3_f32 v248, v248, v222, v223
    v_max3_f32 v248, v248, v224, v225
    v_max3_f32 v248, v248, v226, v227
    v_max3_f32 v248, v248, v228, v229
    v_max3_f32 v248, v248, v230, v231
    s_add_u32 s69, s69, 4096
    s_cmp_lt_u32 s69, 0x40000
    s_cbranch_scc1 L_fbmax17
    v_mov_b32 v249, v248
    s_nop 1
    v_permlane32_swap_b32 v248, v249
    s_nop 1
    v_max_f32 v248, v248, v249
    v_sub_f32 v232, 0, v248
    v_mov_b32 v96, 0
    v_sub_f32 v233, 0, v248
    v_mov_b32 v97, 0
    v_sub_f32 v234, 0, v248
    v_mov_b32 v98, 0
    v_sub_f32 v235, 0, v248
    v_mov_b32 v99, 0
    v_sub_f32 v236, 0, v248
    v_mov_b32 v100, 0
    v_sub_f32 v237, 0, v248
    v_mov_b32 v101, 0
    v_sub_f32 v238, 0, v248
    v_mov_b32 v102, 0
    v_sub_f32 v239, 0, v248
    v_mov_b32 v103, 0
    v_sub_f32 v240, 0, v248
    v_mov_b32 v104, 0
    v_sub_f32 v241, 0, v248
    v_mov_b32 v105, 0
    v_sub_f32 v242, 0, v248
    v_mov_b32 v106, 0
    v_sub_f32 v243, 0, v248
    v_mov_b32 v107, 0
    v_sub_f32 v244, 0, v248
    v_mov_b32 v108, 0
    v_sub_f32 v245, 0, v248
    v_mov_b32 v109, 0
    v_sub_f32 v246, 0, v248
    v_mov_b32 v110, 0
    v_sub_f32 v247, 0, v248
    v_mov_b32 v111, 0
    v_mov_b32 v128, 0
    v_mov_b32 v129, 0
    v_mov_b32 v130, 0
    v_mov_b32 v131, 0
    v_and_b32 v250, 7, v0
    v_mov_b32 v251, 0x3f803f80
    v_cmp_eq_u32 vcc, 0, v250
    s_nop 1
    v_cndmask_b32 v252, 0, v251, vcc
    v_cndmask_b32 v253, 0, v251, vcc
    v_cmp_eq_u32 vcc, 4, v250
    s_nop 1
    v_cndmask_b32 v254, 0, v251, vcc
    v_cndmask_b32 v255, 0, v251, vcc
    s_mov_b32 s69, 0
L_fbsum18:
    buffer_load_dwordx4 v[200:203], v37, s[28:31], s69 offen offset:0 sc1
    buffer_load_dwordx4 v[204:207], v37, s[28:31], s69 offen offset:1024 sc1
    buffer_load_dwordx4 v[208:211], v37, s[28:31], s69 offen offset:2048 sc1
    buffer_load_dwordx4 v[212:215], v37, s[28:31], s69 offen offset:3072 sc1
    s_waitcnt vmcnt(0)
    v_mfma_f32_32x32x16_bf16 v[216:231], v[200:203], v[184:187], v[232:247]
    v_mfma_f32_32x32x16_bf16 v[216:231], v[204:207], v[188:191], v[216:231]
    s_nop 15
    v_exp_f32 v216, v216
    v_exp_f32 v217, v217
    v_exp_f32 v218, v218
    v_exp_f32 v219, v219
    v_exp_f32 v220, v220
    v_exp_f32 v221, v221
    v_exp_f32 v222, v222
    v_exp_f32 v223, v223
    v_exp_f32 v224, v224
    v_exp_f32 v225, v225
    v_exp_f32 v226, v226
    v_exp_f32 v227, v227
    v_exp_f32 v228, v228
    v_exp_f32 v229, v229
    v_exp_f32 v230, v230
    v_exp_f32 v231, v231
    s_nop 1
    v_smfmac_f32_32x32x32_bf16 v[96:111], v[208:211], v[216:223], v44
    v_smfmac_f32_16x16x64_bf16 v[128:131], v[252:255], v[216:223], v44
    v_smfmac_f32_32x32x32_bf16 v[96:111], v[212:215], v[224:231], v44
    v_smfmac_f32_16x16x64_bf16 v[128:131], v[252:255], v[224:231], v44
    s_nop 15
    s_add_u32 s69, s69, 4096
    s_cmp_lt_u32 s69, 0x40000
    s_cbranch_scc1 L_fbsum18
    v_mov_b32 v248, 0x7fc00000
    v_cmp_u_f32 vcc, v96, v96
    s_nop 1
    v_cndmask_b32 v96, v96, v248, vcc
    v_cmp_u_f32 vcc, v97, v97
    s_nop 1
    v_cndmask_b32 v97, v97, v248, vcc
    v_cmp_u_f32 vcc, v98, v98
    s_nop 1
    v_cndmask_b32 v98, v98, v248, vcc
    v_cmp_u_f32 vcc, v99, v99
    s_nop 1
    v_cndmask_b32 v99, v99, v248, vcc
    v_cmp_u_f32 vcc, v100, v100
    s_nop 1
    v_cndmask_b32 v100, v100, v248, vcc
    v_cmp_u_f32 vcc, v101, v101
    s_nop 1
    v_cndmask_b32 v101, v101, v248, vcc
    v_cmp_u_f32 vcc, v102, v102
    s_nop 1
    v_cndmask_b32 v102, v102, v248, vcc
    v_cmp_u_f32 vcc, v103, v103
    s_nop 1
    v_cndmask_b32 v103, v103, v248, vcc
    v_cmp_u_f32 vcc, v104, v104
    s_nop 1
    v_cndmask_b32 v104, v104, v248, vcc
    v_cmp_u_f32 vcc, v105, v105
    s_nop 1
    v_cndmask_b32 v105, v105, v248, vcc
    v_cmp_u_f32 vcc, v106, v106
    s_nop 1
    v_cndmask_b32 v106, v106, v248, vcc
    v_cmp_u_f32 vcc, v107, v107
    s_nop 1
    v_cndmask_b32 v107, v107, v248, vcc
    v_cmp_u_f32 vcc, v108, v108
    s_nop 1
    v_cndmask_b32 v108, v108, v248, vcc
    v_cmp_u_f32 vcc, v109, v109
    s_nop 1
    v_cndmask_b32 v109, v109, v248, vcc
    v_cmp_u_f32 vcc, v110, v110
    s_nop 1
    v_cndmask_b32 v110, v110, v248, vcc
    v_cmp_u_f32 vcc, v111, v111
    s_nop 1
    v_cndmask_b32 v111, v111, v248, vcc
    v_cmp_u_f32 vcc, v128, v128
    s_nop 1
    v_cndmask_b32 v128, v128, v248, vcc
    v_rcp_f32 v46, v128
    s_branch L_fbret16
L_gate0__retry19:
    s_mov_b32 s45, 0
L_gate0__loop21:
    buffer_load_dword v38, v10, s[32:35], 0 offen sc1
    s_add_u32 s45, s45, 1
    s_cmp_gt_u32 s45, 2097152
    s_waitcnt vmcnt(0)
    s_cbranch_scc1 L_gate0__ok20
    v_cmp_eq_u32 vcc, -1, v38
    s_cmp_lg_u64 vcc, 0
    s_cbranch_scc1 L_gate0__loop21
    s_branch L_gate0__ok20
L_fb22:
    s_nop 15
    v_mov_b32 v80, 0xff800000
    s_mov_b32 s69, 0
L_fbmax24:
    buffer_load_dwordx4 a[0:3], v37, s[28:31], s69 offen offset:0 sc1
    buffer_load_dwordx4 a[4:7], v37, s[28:31], s69 offen offset:1024 sc1
    s_waitcnt vmcnt(0)
    v_mfma_f32_32x32x16_bf16 v[48:63], a[0:3], v[192:195], 0
    v_mfma_f32_32x32x16_bf16 v[48:63], a[4:7], v[196:199], v[48:63]
    s_nop 15
    v_max3_f32 v80, v80, v48, v49
    v_max3_f32 v80, v80, v50, v51
    v_max3_f32 v80, v80, v52, v53
    v_max3_f32 v80, v80, v54, v55
    v_max3_f32 v80, v80, v56, v57
    v_max3_f32 v80, v80, v58, v59
    v_max3_f32 v80, v80, v60, v61
    v_max3_f32 v80, v80, v62, v63
    s_add_u32 s69, s69, 4096
    s_cmp_lt_u32 s69, 0x40000
    s_cbranch_scc1 L_fbmax24
    v_mov_b32 v81, v80
    s_nop 1
    v_permlane32_swap_b32 v80, v81
    s_nop 1
    v_max_f32 v80, v80, v81
    v_sub_f32 v64, 0, v80
    v_mov_b32 v112, 0
    v_sub_f32 v65, 0, v80
    v_mov_b32 v113, 0
    v_sub_f32 v66, 0, v80
    v_mov_b32 v114, 0
    v_sub_f32 v67, 0, v80
    v_mov_b32 v115, 0
    v_sub_f32 v68, 0, v80
    v_mov_b32 v116, 0
    v_sub_f32 v69, 0, v80
    v_mov_b32 v117, 0
    v_sub_f32 v70, 0, v80
    v_mov_b32 v118, 0
    v_sub_f32 v71, 0, v80
    v_mov_b32 v119, 0
    v_sub_f32 v72, 0, v80
    v_mov_b32 v120, 0
    v_sub_f32 v73, 0, v80
    v_mov_b32 v121, 0
    v_sub_f32 v74, 0, v80
    v_mov_b32 v122, 0
    v_sub_f32 v75, 0, v80
    v_mov_b32 v123, 0
    v_sub_f32 v76, 0, v80
    v_mov_b32 v124, 0
    v_sub_f32 v77, 0, v80
    v_mov_b32 v125, 0
    v_sub_f32 v78, 0, v80
    v_mov_b32 v126, 0
    v_sub_f32 v79, 0, v80
    v_mov_b32 v127, 0
    v_mov_b32 v132, 0
    v_mov_b32 v133, 0
    v_mov_b32 v134, 0
    v_mov_b32 v135, 0
    v_and_b32 v82, 7, v0
    v_mov_b32 v83, 0x3f803f80
    v_cmp_eq_u32 vcc, 0, v82
    s_nop 1
    v_cndmask_b32 v84, 0, v83, vcc
    v_cndmask_b32 v85, 0, v83, vcc
    v_cmp_eq_u32 vcc, 4, v82
    s_nop 1
    v_cndmask_b32 v86, 0, v83, vcc
    v_cndmask_b32 v87, 0, v83, vcc
    s_mov_b32 s69, 0
L_fbsum25:
    buffer_load_dwordx4 a[0:3], v37, s[28:31], s69 offen offset:0 sc1
    buffer_load_dwordx4 a[4:7], v37, s[28:31], s69 offen offset:1024 sc1
    buffer_load_dwordx4 a[8:11], v37, s[28:31], s69 offen offset:2048 sc1
    buffer_load_dwordx4 a[12:15], v37, s[28:31], s69 offen offset:3072 sc1
    s_waitcnt vmcnt(0)
    v_mfma_f32_32x32x16_bf16 v[48:63], a[0:3], v[192:195], v[64:79]
    v_mfma_f32_32x32x16_bf16 v[48:63], a[4:7], v[196:199], v[48:63]
    s_nop 15
    v_exp_f32 v48, v48
    v_exp_f32 v49, v49
    v_exp_f32 v50, v50
    v_exp_f32 v51, v51
    v_exp_f32 v52, v52
    v_exp_f32 v53, v53
    v_exp_f32 v54, v54
    v_exp_f32 v55, v55
    v_exp_f32 v56, v56
    v_exp_f32 v57, v57
    v_exp_f32 v58, v58
    v_exp_f32 v59, v59
    v_exp_f32 v60, v60
    v_exp_f32 v61, v61
    v_exp_f32 v62, v62
    v_exp_f32 v63, v63
    s_nop 1
    v_smfmac_f32_32x32x32_bf16 v[112:127], a[8:11], v[48:55], v44
    v_smfmac_f32_16x16x64_bf16 v[132:135], v[84:87], v[48:55], v44
    v_smfmac_f32_32x32x32_bf16 v[112:127], a[12:15], v[56:63], v44
    v_smfmac_f32_16x16x64_bf16 v[132:135], v[84:87], v[56:63], v44
    s_nop 15
    s_add_u32 s69, s69, 4096
    s_cmp_lt_u32 s69, 0x40000
    s_cbranch_scc1 L_fbsum25
    v_mov_b32 v80, 0x7fc00000
    v_cmp_u_f32 vcc, v112, v112
    s_nop 1
    v_cndmask_b32 v112, v112, v80, vcc
    v_cmp_u_f32 vcc, v113, v113
    s_nop 1
    v_cndmask_b32 v113, v113, v80, vcc
    v_cmp_u_f32 vcc, v114, v114
    s_nop 1
    v_cndmask_b32 v114, v114, v80, vcc
    v_cmp_u_f32 vcc, v115, v115
    s_nop 1
    v_cndmask_b32 v115, v115, v80, vcc
    v_cmp_u_f32 vcc, v116, v116
    s_nop 1
    v_cndmask_b32 v116, v116, v80, vcc
    v_cmp_u_f32 vcc, v117, v117
    s_nop 1
    v_cndmask_b32 v117, v117, v80, vcc
    v_cmp_u_f32 vcc, v118, v118
    s_nop 1
    v_cndmask_b32 v118, v118, v80, vcc
    v_cmp_u_f32 vcc, v119, v119
    s_nop 1
    v_cndmask_b32 v119, v119, v80, vcc
    v_cmp_u_f32 vcc, v120, v120
    s_nop 1
    v_cndmask_b32 v120, v120, v80, vcc
    v_cmp_u_f32 vcc, v121, v121
    s_nop 1
    v_cndmask_b32 v121, v121, v80, vcc
    v_cmp_u_f32 vcc, v122, v122
    s_nop 1
    v_cndmask_b32 v122, v122, v80, vcc
    v_cmp_u_f32 vcc, v123, v123
    s_nop 1
    v_cndmask_b32 v123, v123, v80, vcc
    v_cmp_u_f32 vcc, v124, v124
    s_nop 1
    v_cndmask_b32 v124, v124, v80, vcc
    v_cmp_u_f32 vcc, v125, v125
    s_nop 1
    v_cndmask_b32 v125, v125, v80, vcc
    v_cmp_u_f32 vcc, v126, v126
    s_nop 1
    v_cndmask_b32 v126, v126, v80, vcc
    v_cmp_u_f32 vcc, v127, v127
    s_nop 1
    v_cndmask_b32 v127, v127, v80, vcc
    v_cmp_u_f32 vcc, v132, v132
    s_nop 1
    v_cndmask_b32 v132, v132, v80, vcc
    v_rcp_f32 v46, v132
    s_branch L_fbret23
L_gate1__retry26:
    s_mov_b32 s45, 0
L_gate1__loop28:
    buffer_load_dword v38, v10, s[32:35], s43 offen sc1
    s_add_u32 s45, s45, 1
    s_cmp_gt_u32 s45, 2097152
    s_waitcnt vmcnt(0)
    s_cbranch_scc1 L_gate1__ok27
    v_cmp_eq_u32 vcc, -1, v38
    s_cmp_lg_u64 vcc, 0
    s_cbranch_scc1 L_gate1__loop28
    s_branch L_gate1__ok27
L_epi:
    v_cvt_pk_bf16_f32 v48, v48, v49
    v_cvt_pk_bf16_f32 v49, v50, v51
    ds_write_b64 v11, v[48:49] offset:0
    v_cvt_pk_bf16_f32 v56, v56, v57
    v_cvt_pk_bf16_f32 v57, v58, v59
    ds_write_b64 v11, v[56:57] offset:32
    v_cvt_pk_bf16_f32 v64, v64, v65
    v_cvt_pk_bf16_f32 v65, v66, v67
    ds_write_b64 v11, v[64:65] offset:64
    v_cvt_pk_bf16_f32 v72, v72, v73
    v_cvt_pk_bf16_f32 v73, v74, v75
    ds_write_b64 v11, v[72:73] offset:96
    ds_read_b128 v[80:83], v12 offset:0
    ds_read_b128 v[84:87], v12 offset:1152
    s_waitcnt lgkmcnt(1)
    buffer_store_dwordx4 v[80:83], v13, s[20:23], 0 offen sc0 sc1
    s_mov_b32 s40, 16384
    s_waitcnt lgkmcnt(0)
    buffer_store_dwordx4 v[84:87], v13, s[20:23], s40 offen sc0 sc1
    v_cvt_pk_bf16_f32 v52, v52, v53
    v_cvt_pk_bf16_f32 v53, v54, v55
    ds_write_b64 v11, v[52:53] offset:2304
    v_cvt_pk_bf16_f32 v60, v60, v61
    v_cvt_pk_bf16_f32 v61, v62, v63
    ds_write_b64 v11, v[60:61] offset:2336
    v_cvt_pk_bf16_f32 v68, v68, v69
    v_cvt_pk_bf16_f32 v69, v70, v71
    ds_write_b64 v11, v[68:69] offset:2368
    v_cvt_pk_bf16_f32 v76, v76, v77
    v_cvt_pk_bf16_f32 v77, v78, v79
    ds_write_b64 v11, v[76:77] offset:2400
    ds_read_b128 v[88:91], v12 offset:2304
    ds_read_b128 v[92:95], v12 offset:3456
    s_mov_b32 s40, 32768
    s_waitcnt lgkmcnt(1)
    buffer_store_dwordx4 v[88:91], v13, s[20:23], s40 offen sc0 sc1
    s_mov_b32 s40, 49152
    s_waitcnt lgkmcnt(0)
    buffer_store_dwordx4 v[92:95], v13, s[20:23], s40 offen sc0 sc1
    s_branch L_done
L_slow:
    s_waitcnt vmcnt(0) lgkmcnt(0)
    s_nop 7
    v_mov_b32 v48, 0
    v_mov_b32 v49, 0
    v_mov_b32 v50, 0
    v_mov_b32 v51, 0
    v_mov_b32 v52, 0
    v_mov_b32 v53, 0
    v_mov_b32 v54, 0
    v_mov_b32 v55, 0
    v_mov_b32 v56, 0
    v_mov_b32 v57, 0
    v_mov_b32 v58, 0
    v_mov_b32 v59, 0
    v_mov_b32 v60, 0
    v_mov_b32 v61, 0
    v_mov_b32 v62, 0
    v_mov_b32 v63, 0
    v_mov_b32 v64, 0
    v_mov_b32 v65, 0
    v_mov_b32 v66, 0
    v_mov_b32 v67, 0
    v_mov_b32 v68, 0
    v_mov_b32 v69, 0
    v_mov_b32 v70, 0
    v_mov_b32 v71, 0
    v_mov_b32 v72, 0
    v_mov_b32 v73, 0
    v_mov_b32 v74, 0
    v_mov_b32 v75, 0
    v_mov_b32 v76, 0
    v_mov_b32 v77, 0
    v_mov_b32 v78, 0
    v_mov_b32 v79, 0
    v_add_u32 v16, 61440, v16
    v_add_u32 v17, 61440, v17
    v_add_u32 v18, 61440, v18
    v_add_u32 v19, 61440, v19
    s_lshl_b32 s42, s38, 16
    s_mov_b32 s69, 0
    s_mov_b32 s45, 0
L_slow_loop:
    buffer_load_dwordx4 v[80:83], v37, s[32:35], s42 offen offset:0 sc1
    buffer_load_dwordx4 v[84:87], v37, s[32:35], s42 offen offset:1024 sc1
    s_add_u32 s45, s45, 1
    s_waitcnt vmcnt(0)
    v_max3_u32 v1, v80, v81, v82
    v_max3_u32 v1, v1, v83, v84
    v_max3_u32 v1, v1, v85, v86
    v_max_u32 v1, v1, v87
    v_cmp_eq_u32 vcc, -1, v1
    s_cmp_gt_u32 s45, 2097152
    s_cbranch_scc1 L_slow_go
    s_cmp_lg_u64 vcc, 0
    s_cbranch_scc1 L_slow_loop
L_slow_go:
    ds_read_b64_tr_b16 a[128:129], v16 offset:0
    ds_read_b64_tr_b16 a[130:131], v16 offset:1024
    ds_read_b64_tr_b16 a[132:133], v17 offset:0
    ds_read_b64_tr_b16 a[134:135], v17 offset:1024
    ds_read_b64_tr_b16 a[136:137], v18 offset:0
    ds_read_b64_tr_b16 a[138:139], v18 offset:1024
    ds_read_b64_tr_b16 a[140:141], v19 offset:0
    ds_read_b64_tr_b16 a[142:143], v19 offset:1024
    s_waitcnt lgkmcnt(0)
    v_subrev_u32 v16, 4096, v16
    v_mfma_f32_16x16x32_bf16 v[48:51], a[128:131], v[80:83], v[48:51]
    v_mfma_f32_16x16x32_bf16 v[52:55], a[128:131], v[84:87], v[52:55]
    v_subrev_u32 v17, 4096, v17
    v_mfma_f32_16x16x32_bf16 v[56:59], a[132:135], v[80:83], v[56:59]
    v_mfma_f32_16x16x32_bf16 v[60:63], a[132:135], v[84:87], v[60:63]
    v_subrev_u32 v18, 4096, v18
    v_mfma_f32_16x16x32_bf16 v[64:67], a[136:139], v[80:83], v[64:67]
    v_mfma_f32_16x16x32_bf16 v[68:71], a[136:139], v[84:87], v[68:71]
    v_subrev_u32 v19, 4096, v19
    v_mfma_f32_16x16x32_bf16 v[72:75], a[140:143], v[80:83], v[72:75]
    v_mfma_f32_16x16x32_bf16 v[76:79], a[140:143], v[84:87], v[76:79]
    s_nop 7
    s_add_u32 s42, s42, 2048
    s_add_u32 s69, s69, 1
    s_cmp_lt_u32 s69, 32
    s_cbranch_scc1 L_slow_loop
    s_branch L_epi
L_end:
    s_endpgm
.if (. - standalone__grouped_kv_mqa__prompt_kernel) < 0x8240
.fill (0x8240 - (. - standalone__grouped_kv_mqa__prompt_kernel)) / 4, 4, 0xbf810000
.endif
.section .rodata,"a"
.p2align 6
.amdhsa_kernel standalone__grouped_kv_mqa__prompt_kernel
  .amdhsa_next_free_vgpr 512
  .amdhsa_next_free_sgpr 102
  .amdhsa_accum_offset 256
  .amdhsa_group_segment_fixed_size 0
  .amdhsa_kernarg_size 64
  .amdhsa_user_sgpr_count 2
  .amdhsa_user_sgpr_kernarg_segment_ptr 1
  .amdhsa_system_sgpr_workgroup_id_x 1
.end_amdhsa_kernel
```
